```python
import torch

def _softmax(x, axis=-1):
    return torch.softmax(x, dim=axis)

def _gelu(x):
    return torch.nn.functional.gelu(x, approximate='tanh')

def _silu(x):
    return torch.nn.functional.silu(x)

def _sigmoid(x):
    return torch.sigmoid(x)

def _layernorm(x, axis=-1, eps=1e-05):
    m = x.mean(dim=axis, keepdim=True)
    v = x.var(dim=axis, keepdim=True, unbiased=False)
    return (x - m) / torch.sqrt(v + eps)

def _scatter_add(tgt, idx, src, axis=0):
    return tgt.clone().index_add_(axis, idx, src)

def _segment_sum(src, seg, n):
    out = torch.zeros((n,) + src.shape[1:], dtype=src.dtype)
    return out.index_add_(0, seg, src)

def _pad(x, pw):
    flat = tuple((v for pair in reversed(pw) for v in pair))
    return torch.nn.functional.pad(x, flat)
kernel_name = 'adaLN_cond__softmax_full_mha__dense_activation_silu__prompt'

def setup_inputs():

    _w = lambda a: (lambda t: t.to(torch.bfloat16) if t.is_floating_point() else t)(torch.as_tensor(a))

    def _A_setup():
        B, S, D = (1, 2048, 448)
        return {'x': _w((lambda *s: torch.randn(*s, dtype=torch.bfloat16) * 0.05)(B, S, D)), 'wqkv': _w((lambda *s: torch.randn(*s, dtype=torch.bfloat16) * 0.05)(D, 3 * D)), 'wo': _w((lambda *s: torch.randn(*s, dtype=torch.bfloat16) * 0.05)(D, D))}
    _A_in = _A_setup()

    def _B_setup():
        B, S, D, F = (1, 2048, 448, 1792)
        return {'x': _w((lambda *s: torch.randn(*s, dtype=torch.bfloat16) * 0.05)(B, S, D)), 'w1': _w((lambda *s: torch.randn(*s, dtype=torch.bfloat16) * 3.2)(D, F) * D ** (-0.5)), 'w2': _w((lambda *s: torch.randn(*s, dtype=torch.bfloat16) * 0.2)(F, D) * F ** (-0.5))}
    _B_in = _B_setup()
    return {'A_x': _A_in['x'], 'A_wqkv': _A_in['wqkv'], 'A_wo': _A_in['wo'], 'B_x': _B_in['x'], 'B_w1': _B_in['w1'], 'B_w2': _B_in['w2'], 'c': _w((lambda *s: torch.randn(*s, dtype=torch.bfloat16) * 0.1)(1, 448) * 8.0), 'w_mod': _w((lambda *s: torch.randn(*s, dtype=torch.bfloat16) * 0.1)(448, 6 * 448) * 448 ** (-0.5) * 8.0)}

def reference(A_x, A_wqkv, A_wo, B_x, B_w1, B_w2, c, w_mod):

    def _A_ref(x, wqkv, wo):
        B, S, D = x.shape
        H = 16
        Dh = D // H
        qkv = (lambda x, *d: x.permute(*d))((x @ wqkv).reshape(B, S, 3, H, Dh), 2, 0, 3, 1, 4)
        q, k, v = (qkv[0], qkv[1], qkv[2])
        scale = Dh ** (-0.5)
        scores = torch.einsum('bhqd,bhkd->bhqk', q, k) * scale
        p = _softmax(scores, axis=-1)
        o = torch.einsum('bhqk,bhkd->bhqd', p, v)
        return (lambda x, *d: x.permute(*d))(o, 0, 2, 1, 3).reshape(B, S, D) @ wo

    def _B_ref(x, w1, w2):
        h = torch.einsum('bsd,df->bsf', x, w1)
        h = _silu(h)
        out = torch.einsum('bsf,fd->bsd', h, w2)
        return out
    x = A_x
    mod = (_silu(c) @ w_mod).reshape(c.shape[0], 6, 1, -1)
    sa, ca, ga, sb, cb, gb = (mod[:, 0].clone(), mod[:, 1].clone(), mod[:, 2].clone(), mod[:, 3].clone(), mod[:, 4].clone(), mod[:, 5].clone())
    h = _layernorm(x, axis=-1) * (1 + ca) + sa
    x = x + ga * _A_ref(h, A_wqkv, A_wo)
    h = _layernorm(x, axis=-1) * (1 + cb) + sb
    x = x + gb * _B_ref(h, B_w1, B_w2)
    return x
```

```asm
; @launch kernel=prep_kernel grid=(125,1,1) block=(512,1,1) lds=65536
; @launch kernel=qkv_kernel grid=(256,1,1) block=(512,1,1) lds=73728
; @launch kernel=attn_kernel grid=(256,1,1) block=(256,1,1) lds=131136
; @launch kernel=wo_kernel grid=(224,1,1) block=(512,1,1) lds=139264
; @launch kernel=mlp1_kernel grid=(256,1,1) block=(512,1,1) lds=73728
; @launch kernel=mlp2_kernel grid=(224,1,1) block=(512,1,1) lds=139264
.amdgcn_target "amdgcn-amd-amdhsa--gfx950"
.text
.globl prep_kernel
.p2align 8
.type prep_kernel,@function
prep_kernel:
    s_cmp_ge_u32 s2, 125
    s_cbranch_scc1 prep_kernel_end
    s_load_dwordx16 s[16:31], s[0:1], 0
    s_load_dwordx4 s[32:35], s[0:1], 64
    s_load_dwordx2 s[36:37], s[0:1], 80
    v_and_b32 v1, 7, v0
    v_bfe_u32 v2, v0, 3, 1
    v_lshrrev_b32 v3, 4, v0
    s_waitcnt lgkmcnt(0)
    s_cmp_lt_u32 s2, 21
    s_cbranch_scc1 prep_mod
    s_mov_b32 s60, 0x05040100
    s_mov_b32 s61, 0x07060302
    s_cmp_lt_u32 s2, 69
    s_cbranch_scc1 prep_qkv
    v_lshrrev_b32 v40, 6, v0
    v_and_b32 v41, 63, v0
    v_readfirstlane_b32 s40, v40
    v_lshlrev_b32 v42, 4, v41
    s_sub_u32 s72, s2, 69
    s_lshl_b32 s72, s72, 3
    s_add_u32 s72, s72, s40
    s_lshl_b32 s92, s40, 13
    s_cmp_lt_u32 s72, 56
    s_cbranch_scc1 prep_r2_wo
    s_cmp_lt_u32 s72, 252
    s_cbranch_scc1 prep_r2_w1
    s_sub_u32 s74, s72, 252
    s_mul_i32 s75, s74, 2341
    s_lshr_b32 s75, s75, 16
    s_mul_i32 s76, s75, 28
    s_sub_u32 s76, s74, s76
    s_mov_b32 s84, s26
    s_mov_b32 s85, s27
    s_mov_b32 s86, 0x188000
    s_mov_b32 s87, 0x20000
    s_mov_b32 s77, 896
    s_mov_b32 s78, 32
    s_mov_b32 s79, 4
    s_mov_b32 s80, 112
    s_mov_b32 s81, 0x360000
    s_mov_b32 s82, 0
    s_branch prep_r2_go
prep_r2_w1:
    s_sub_u32 s74, s72, 56
    s_mul_i32 s75, s74, 9363
    s_lshr_b32 s75, s75, 16
    s_mul_i32 s76, s75, 7
    s_sub_u32 s76, s74, s76
    s_mov_b32 s84, s24
    s_mov_b32 s85, s25
    s_mov_b32 s86, 0x188000
    s_mov_b32 s87, 0x20000
    s_mov_b32 s77, 3584
    s_mov_b32 s78, 32
    s_mov_b32 s79, 8
    s_mov_b32 s80, 28
    s_mov_b32 s81, 0x1d0000
    s_mov_b32 s82, 0
    s_branch prep_r2_go
prep_r2_wo:
    s_lshr_b32 s75, s72, 3
    s_and_b32 s76, s72, 7
    s_mov_b32 s84, s20
    s_mov_b32 s85, s21
    s_mov_b32 s86, 0x62000
    s_mov_b32 s87, 0x20000
    s_mov_b32 s77, 896
    s_mov_b32 s78, 28
    s_mov_b32 s79, 4
    s_mov_b32 s80, 32
    s_mov_b32 s81, 0x160000
    s_mov_b32 s82, 1
prep_r2_go:
    s_mov_b32 s88, s36
    s_mov_b32 s89, s37
    s_mov_b32 s90, 0x4e8000
    s_mov_b32 s91, 0x20000
    s_lshl_b32 s83, s75, 1
    s_mul_i32 s83, s83, s80
    s_lshl_b32 s74, s76, 2
    s_add_u32 s83, s83, s74
    s_lshl_b32 s83, s83, 10
    s_add_u32 s81, s81, s83
    s_lshl_b32 s80, s80, 10
    s_add_u32 s80, s81, s80
    v_and_b32 v48, 7, v41
    v_bfe_u32 v49, v41, 3, 1
    v_lshrrev_b32 v50, 4, v41
    v_add_u32 v51, s74, v50
    v_lshrrev_b32 v52, 1, v51
    v_mul_lo_u32 v52, v52, s78
    v_and_b32 v53, 1, v51
    v_lshl_add_u32 v52, v53, 4, v52
    v_mul_lo_u32 v54, v49, s79
    v_add_u32 v52, v52, v54
    v_mul_lo_u32 v52, v52, s77
    v_lshl_add_u32 v52, v48, 4, v52
    s_lshl_b32 s83, s75, 7
    v_add_u32 v52, s83, v52
    s_sub_u32 s83, 12, s79
    s_mul_i32 s83, s83, s77
    v_add_u32 v54, s83, v52
    v_and_b32 v53, v53, v49
    v_and_b32 v53, s82, v53
    v_mov_b32 v55, 0x7f000000
    v_cmp_eq_u32 vcc, 1, v53
    s_lshl_b32 s78, s77, 1
    s_add_u32 s79, s78, s77
    v_cndmask_b32 v54, v54, v55, vcc
    buffer_load_dwordx4 v[56:59], v52, s[84:87], 0 offen
    buffer_load_dwordx4 v[60:63], v52, s[84:87], s77 offen
    buffer_load_dwordx4 v[64:67], v52, s[84:87], s78 offen
    buffer_load_dwordx4 v[68:71], v52, s[84:87], s79 offen
    buffer_load_dwordx4 v[72:75], v54, s[84:87], 0 offen
    buffer_load_dwordx4 v[76:79], v54, s[84:87], s77 offen
    buffer_load_dwordx4 v[80:83], v54, s[84:87], s78 offen
    buffer_load_dwordx4 v[84:87], v54, s[84:87], s79 offen
    s_mov_b32 s74, 0x05040100
    s_mov_b32 s75, 0x07060302
    v_lshrrev_b32 v51, 2, v48
    v_lshlrev_b32 v51, 12, v51
    v_lshl_add_u32 v51, v50, 10, v51
    v_lshl_add_u32 v51, v49, 9, v51
    v_and_b32 v53, 3, v48
    v_lshl_add_u32 v51, v53, 7, v51
    v_add_u32 v51, s92, v51
    v_add_u32 v49, s92, v42
    s_waitcnt vmcnt(0)
    v_perm_b32 v88, v60, v56, s74
    v_perm_b32 v89, v68, v64, s74
    v_perm_b32 v90, v76, v72, s74
    v_perm_b32 v91, v84, v80, s74
    v_perm_b32 v92, v60, v56, s75
    v_perm_b32 v93, v68, v64, s75
    v_perm_b32 v94, v76, v72, s75
    v_perm_b32 v95, v84, v80, s75
    v_perm_b32 v96, v61, v57, s74
    v_perm_b32 v97, v69, v65, s74
    v_perm_b32 v98, v77, v73, s74
    v_perm_b32 v99, v85, v81, s74
    v_perm_b32 v100, v61, v57, s75
    v_perm_b32 v101, v69, v65, s75
    v_perm_b32 v102, v77, v73, s75
    v_perm_b32 v103, v85, v81, s75
    v_perm_b32 v104, v62, v58, s74
    v_perm_b32 v105, v70, v66, s74
    v_perm_b32 v106, v78, v74, s74
    v_perm_b32 v107, v86, v82, s74
    v_perm_b32 v108, v62, v58, s75
    v_perm_b32 v109, v70, v66, s75
    v_perm_b32 v110, v78, v74, s75
    v_perm_b32 v111, v86, v82, s75
    v_perm_b32 v112, v63, v59, s74
    v_perm_b32 v113, v71, v67, s74
    v_perm_b32 v114, v79, v75, s74
    v_perm_b32 v115, v87, v83, s74
    v_perm_b32 v116, v63, v59, s75
    v_perm_b32 v117, v71, v67, s75
    v_perm_b32 v118, v79, v75, s75
    v_perm_b32 v119, v87, v83, s75
    ds_write_b128 v51, v[88:91] offset:0
    ds_write_b128 v51, v[92:95] offset:16
    ds_write_b128 v51, v[96:99] offset:32
    ds_write_b128 v51, v[100:103] offset:48
    ds_write_b128 v51, v[104:107] offset:64
    ds_write_b128 v51, v[108:111] offset:80
    ds_write_b128 v51, v[112:115] offset:96
    ds_write_b128 v51, v[116:119] offset:112
    s_waitcnt lgkmcnt(0)
    ds_read_b128 v[88:91], v49 offset:0
    ds_read_b128 v[92:95], v49 offset:1024
    ds_read_b128 v[96:99], v49 offset:2048
    ds_read_b128 v[100:103], v49 offset:3072
    ds_read_b128 v[104:107], v49 offset:4096
    ds_read_b128 v[108:111], v49 offset:5120
    ds_read_b128 v[112:115], v49 offset:6144
    ds_read_b128 v[116:119], v49 offset:7168
    s_waitcnt lgkmcnt(7)
    buffer_store_dwordx4 v[88:91], v42, s[88:91], s81 offen offset:0
    s_waitcnt lgkmcnt(6)
    buffer_store_dwordx4 v[92:95], v42, s[88:91], s81 offen offset:1024
    s_waitcnt lgkmcnt(5)
    buffer_store_dwordx4 v[96:99], v42, s[88:91], s81 offen offset:2048
    s_waitcnt lgkmcnt(4)
    buffer_store_dwordx4 v[100:103], v42, s[88:91], s81 offen offset:3072
    s_waitcnt lgkmcnt(3)
    buffer_store_dwordx4 v[104:107], v42, s[88:91], s80 offen offset:0
    s_waitcnt lgkmcnt(2)
    buffer_store_dwordx4 v[108:111], v42, s[88:91], s80 offen offset:1024
    s_waitcnt lgkmcnt(1)
    buffer_store_dwordx4 v[112:115], v42, s[88:91], s80 offen offset:2048
    s_waitcnt lgkmcnt(0)
    buffer_store_dwordx4 v[116:119], v42, s[88:91], s80 offen offset:3072
    s_cmp_ge_u32 s2, 85
    s_cbranch_scc1 prep_nopf
    s_getpc_b64 s[94:95]
prep_pc:
    s_add_u32 s94, s94, qkv_kernel-prep_pc
    s_addc_u32 s95, s95, 0
    v_lshlrev_b32 v43, 6, v0
    global_load_dword v44, v43, s[94:95]
    v_add_u32 v43, 0x8000, v43
    v_cmp_gt_u32 vcc, (mlp2_kernel_end-qkv_kernel), v43
    s_and_saveexec_b64 s[96:97], vcc
    s_cbranch_execz prep_nopf
    global_load_dword v45, v43, s[94:95]
prep_nopf:
    s_endpgm
prep_qkv:
    s_sub_u32 s56, s2, 21
    s_mul_i32 s57, s56, 171
    s_lshr_b32 s57, s57, 9
    s_mul_i32 s58, s57, 3
    s_sub_u32 s58, s56, s58
    s_mul_i32 s58, s58, 896
    s_mul_i32 s57, s57, 56
    s_add_u32 s58, s58, s57
    s_mov_b32 s40, s18
    s_mov_b32 s41, s19
    s_mov_b32 s42, 0x126000
    s_mov_b32 s43, 0x20000
    s_add_u32 s44, s36, 0x10000
    s_addc_u32 s45, s37, 0
    s_mov_b32 s46, 0x150000
    s_mov_b32 s47, 0x20000
    s_mul_i32 s48, s56, 28672
    v_lshlrev_b32 v4, 4, v3
    v_lshl_add_u32 v4, v2, 3, v4
    s_mov_b32 s59, 2688
    v_mul_lo_u32 v4, v4, s59
    v_lshl_add_u32 v4, v1, 3, v4
    v_add_u32 v4, s58, v4
    v_add_u32 v5, 10752, v4
    v_mov_b32 v7, 0x7f000000
    v_cmp_eq_u32 vcc, 7, v1
    s_nop 1
    v_cndmask_b32 v4, v4, v7, vcc
    v_cndmask_b32 v5, v5, v7, vcc
    s_mov_b32 s50, 2688
    s_mov_b32 s51, 5376
    s_mov_b32 s52, 8064
    v_cmp_gt_u32 vcc, 448, v0
    s_and_saveexec_b64 s[54:55], vcc
    s_cbranch_execz prep_kernel_end
    buffer_load_dwordx2 v[8:9], v4, s[40:43], 0 offen
    buffer_load_dwordx2 v[10:11], v4, s[40:43], s50 offen
    buffer_load_dwordx2 v[12:13], v4, s[40:43], s51 offen
    buffer_load_dwordx2 v[14:15], v4, s[40:43], s52 offen
    buffer_load_dwordx2 v[16:17], v5, s[40:43], 0 offen
    buffer_load_dwordx2 v[18:19], v5, s[40:43], s50 offen
    buffer_load_dwordx2 v[20:21], v5, s[40:43], s51 offen
    buffer_load_dwordx2 v[22:23], v5, s[40:43], s52 offen
    v_lshlrev_b32 v6, 6, v0
    s_waitcnt vmcnt(0)
    v_perm_b32 v24, v10, v8, s60
    v_perm_b32 v25, v14, v12, s60
    v_perm_b32 v26, v18, v16, s60
    v_perm_b32 v27, v22, v20, s60
    v_perm_b32 v28, v10, v8, s61
    v_perm_b32 v29, v14, v12, s61
    v_perm_b32 v30, v18, v16, s61
    v_perm_b32 v31, v22, v20, s61
    v_perm_b32 v32, v11, v9, s60
    v_perm_b32 v33, v15, v13, s60
    v_perm_b32 v34, v19, v17, s60
    v_perm_b32 v35, v23, v21, s60
    v_perm_b32 v36, v11, v9, s61
    v_perm_b32 v37, v15, v13, s61
    v_perm_b32 v38, v19, v17, s61
    v_perm_b32 v39, v23, v21, s61
    ds_write_b128 v6, v[24:27] offset:0
    ds_write_b128 v6, v[28:31] offset:16
    ds_write_b128 v6, v[32:35] offset:32
    ds_write_b128 v6, v[36:39] offset:48
    v_and_b32 v7, 63, v0
    v_lshrrev_b32 v6, 6, v0
    v_lshlrev_b32 v6, 12, v6
    v_lshl_add_u32 v6, v7, 4, v6
    s_waitcnt lgkmcnt(0)
    ds_read_b128 v[24:27], v6 offset:0
    ds_read_b128 v[28:31], v6 offset:1024
    ds_read_b128 v[32:35], v6 offset:2048
    ds_read_b128 v[36:39], v6 offset:3072
    s_waitcnt lgkmcnt(3)
    buffer_store_dwordx4 v[24:27], v6, s[44:47], s48 offen offset:0 sc1
    s_waitcnt lgkmcnt(2)
    buffer_store_dwordx4 v[28:31], v6, s[44:47], s48 offen offset:1024 sc1
    s_waitcnt lgkmcnt(1)
    buffer_store_dwordx4 v[32:35], v6, s[44:47], s48 offen offset:2048 sc1
    s_waitcnt lgkmcnt(0)
    buffer_store_dwordx4 v[36:39], v6, s[44:47], s48 offen offset:3072 sc1
    s_endpgm
prep_mod:
    s_mov_b32 s40, s30
    s_mov_b32 s41, s31
    s_mov_b32 s42, 0x24c000
    s_mov_b32 s43, 0x20000
    s_mov_b32 s44, s28
    s_mov_b32 s45, s29
    s_mov_b32 s46, 0x380
    s_mov_b32 s47, 0x20000
    s_mov_b32 s48, s36
    s_mov_b32 s49, s37
    s_mov_b32 s50, 0x2a00
    s_mov_b32 s51, 0x20000
    v_lshrrev_b32 v1, 6, v0
    v_and_b32 v2, 63, v0
    v_readfirstlane_b32 s56, v1
    s_nop 3
    s_mul_i32 s57, s56, 112
    v_lshlrev_b32 v3, 1, v2
    buffer_load_ushort v4, v3, s[44:47], s57 offen
    s_lshl_b32 s58, s2, 8
    v_lshlrev_b32 v5, 2, v2
    v_add_u32 v5, s58, v5
    s_mul_i32 s59, s56, 301056
    buffer_load_dword v16, v5, s[40:43], s59 offen
    s_add_u32 s59, s59, 5376
    buffer_load_dword v17, v5, s[40:43], s59 offen
    s_add_u32 s59, s59, 5376
    buffer_load_dword v18, v5, s[40:43], s59 offen
    s_add_u32 s59, s59, 5376
    buffer_load_dword v19, v5, s[40:43], s59 offen
    s_add_u32 s59, s59, 5376
    buffer_load_dword v20, v5, s[40:43], s59 offen
    s_add_u32 s59, s59, 5376
    buffer_load_dword v21, v5, s[40:43], s59 offen
    s_add_u32 s59, s59, 5376
    buffer_load_dword v22, v5, s[40:43], s59 offen
    s_add_u32 s59, s59, 5376
    buffer_load_dword v23, v5, s[40:43], s59 offen
    s_add_u32 s59, s59, 5376
    buffer_load_dword v24, v5, s[40:43], s59 offen
    s_add_u32 s59, s59, 5376
    buffer_load_dword v25, v5, s[40:43], s59 offen
    s_add_u32 s59, s59, 5376
    buffer_load_dword v26, v5, s[40:43], s59 offen
    s_add_u32 s59, s59, 5376
    buffer_load_dword v27, v5, s[40:43], s59 offen
    s_add_u32 s59, s59, 5376
    buffer_load_dword v28, v5, s[40:43], s59 offen
    s_add_u32 s59, s59, 5376
    buffer_load_dword v29, v5, s[40:43], s59 offen
    s_add_u32 s59, s59, 5376
    buffer_load_dword v30, v5, s[40:43], s59 offen
    s_add_u32 s59, s59, 5376
    buffer_load_dword v31, v5, s[40:43], s59 offen
    s_add_u32 s59, s59, 5376
    buffer_load_dword v32, v5, s[40:43], s59 offen
    s_add_u32 s59, s59, 5376
    buffer_load_dword v33, v5, s[40:43], s59 offen
    s_add_u32 s59, s59, 5376
    buffer_load_dword v34, v5, s[40:43], s59 offen
    s_add_u32 s59, s59, 5376
    buffer_load_dword v35, v5, s[40:43], s59 offen
    s_add_u32 s59, s59, 5376
    buffer_load_dword v36, v5, s[40:43], s59 offen
    s_add_u32 s59, s59, 5376
    buffer_load_dword v37, v5, s[40:43], s59 offen
    s_add_u32 s59, s59, 5376
    buffer_load_dword v38, v5, s[40:43], s59 offen
    s_add_u32 s59, s59, 5376
    buffer_load_dword v39, v5, s[40:43], s59 offen
    s_add_u32 s59, s59, 5376
    buffer_load_dword v40, v5, s[40:43], s59 offen
    s_add_u32 s59, s59, 5376
    buffer_load_dword v41, v5, s[40:43], s59 offen
    s_add_u32 s59, s59, 5376
    buffer_load_dword v42, v5, s[40:43], s59 offen
    s_add_u32 s59, s59, 5376
    buffer_load_dword v43, v5, s[40:43], s59 offen
    s_add_u32 s59, s59, 5376
    buffer_load_dword v44, v5, s[40:43], s59 offen
    s_add_u32 s59, s59, 5376
    buffer_load_dword v45, v5, s[40:43], s59 offen
    s_add_u32 s59, s59, 5376
    buffer_load_dword v46, v5, s[40:43], s59 offen
    s_add_u32 s59, s59, 5376
    buffer_load_dword v47, v5, s[40:43], s59 offen
    s_add_u32 s59, s59, 5376
    buffer_load_dword v48, v5, s[40:43], s59 offen
    s_add_u32 s59, s59, 5376
    buffer_load_dword v49, v5, s[40:43], s59 offen
    s_add_u32 s59, s59, 5376
    buffer_load_dword v50, v5, s[40:43], s59 offen
    s_add_u32 s59, s59, 5376
    buffer_load_dword v51, v5, s[40:43], s59 offen
    s_add_u32 s59, s59, 5376
    buffer_load_dword v52, v5, s[40:43], s59 offen
    s_add_u32 s59, s59, 5376
    buffer_load_dword v53, v5, s[40:43], s59 offen
    s_add_u32 s59, s59, 5376
    buffer_load_dword v54, v5, s[40:43], s59 offen
    s_add_u32 s59, s59, 5376
    buffer_load_dword v55, v5, s[40:43], s59 offen
    s_add_u32 s59, s59, 5376
    buffer_load_dword v56, v5, s[40:43], s59 offen
    s_add_u32 s59, s59, 5376
    buffer_load_dword v57, v5, s[40:43], s59 offen
    s_add_u32 s59, s59, 5376
    buffer_load_dword v58, v5, s[40:43], s59 offen
    s_add_u32 s59, s59, 5376
    buffer_load_dword v59, v5, s[40:43], s59 offen
    s_add_u32 s59, s59, 5376
    buffer_load_dword v60, v5, s[40:43], s59 offen
    s_add_u32 s59, s59, 5376
    buffer_load_dword v61, v5, s[40:43], s59 offen
    s_add_u32 s59, s59, 5376
    buffer_load_dword v62, v5, s[40:43], s59 offen
    s_add_u32 s59, s59, 5376
    buffer_load_dword v63, v5, s[40:43], s59 offen
    s_add_u32 s59, s59, 5376
    buffer_load_dword v64, v5, s[40:43], s59 offen
    s_add_u32 s59, s59, 5376
    buffer_load_dword v65, v5, s[40:43], s59 offen
    s_add_u32 s59, s59, 5376
    buffer_load_dword v66, v5, s[40:43], s59 offen
    s_add_u32 s59, s59, 5376
    buffer_load_dword v67, v5, s[40:43], s59 offen
    s_add_u32 s59, s59, 5376
    buffer_load_dword v68, v5, s[40:43], s59 offen
    s_add_u32 s59, s59, 5376
    buffer_load_dword v69, v5, s[40:43], s59 offen
    s_add_u32 s59, s59, 5376
    buffer_load_dword v70, v5, s[40:43], s59 offen
    s_add_u32 s59, s59, 5376
    buffer_load_dword v71, v5, s[40:43], s59 offen
    s_add_u32 s59, s59, 5376
    s_waitcnt vmcnt(56)
    v_lshlrev_b32 v4, 16, v4
    v_mul_f32 v6, 0xbfb8aa3b, v4
    v_exp_f32 v6, v6
    s_nop 0
    v_add_f32 v6, 1.0, v6
    v_rcp_f32 v6, v6
    s_nop 0
    v_mul_f32 v6, v4, v6
    v_mov_b32 v8, 0
    v_mov_b32 v9, 0
    v_readlane_b32 s60, v6, 0
    s_waitcnt vmcnt(55)
    v_lshlrev_b32 v10, 16, v16
    v_and_b32 v11, 0xffff0000, v16
    v_fmac_f32 v8, s60, v10
    v_fmac_f32 v9, s60, v11
    v_readlane_b32 s60, v6, 1
    s_waitcnt vmcnt(54)
    v_lshlrev_b32 v10, 16, v17
    v_and_b32 v11, 0xffff0000, v17
    v_fmac_f32 v8, s60, v10
    v_fmac_f32 v9, s60, v11
    v_readlane_b32 s60, v6, 2
    s_waitcnt vmcnt(53)
    v_lshlrev_b32 v10, 16, v18
    v_and_b32 v11, 0xffff0000, v18
    v_fmac_f32 v8, s60, v10
    v_fmac_f32 v9, s60, v11
    v_readlane_b32 s60, v6, 3
    s_waitcnt vmcnt(52)
    v_lshlrev_b32 v10, 16, v19
    v_and_b32 v11, 0xffff0000, v19
    v_fmac_f32 v8, s60, v10
    v_fmac_f32 v9, s60, v11
    v_readlane_b32 s60, v6, 4
    s_waitcnt vmcnt(51)
    v_lshlrev_b32 v10, 16, v20
    v_and_b32 v11, 0xffff0000, v20
    v_fmac_f32 v8, s60, v10
    v_fmac_f32 v9, s60, v11
    v_readlane_b32 s60, v6, 5
    s_waitcnt vmcnt(50)
    v_lshlrev_b32 v10, 16, v21
    v_and_b32 v11, 0xffff0000, v21
    v_fmac_f32 v8, s60, v10
    v_fmac_f32 v9, s60, v11
    v_readlane_b32 s60, v6, 6
    s_waitcnt vmcnt(49)
    v_lshlrev_b32 v10, 16, v22
    v_and_b32 v11, 0xffff0000, v22
    v_fmac_f32 v8, s60, v10
    v_fmac_f32 v9, s60, v11
    v_readlane_b32 s60, v6, 7
    s_waitcnt vmcnt(48)
    v_lshlrev_b32 v10, 16, v23
    v_and_b32 v11, 0xffff0000, v23
    v_fmac_f32 v8, s60, v10
    v_fmac_f32 v9, s60, v11
    v_readlane_b32 s60, v6, 8
    s_waitcnt vmcnt(47)
    v_lshlrev_b32 v10, 16, v24
    v_and_b32 v11, 0xffff0000, v24
    v_fmac_f32 v8, s60, v10
    v_fmac_f32 v9, s60, v11
    v_readlane_b32 s60, v6, 9
    s_waitcnt vmcnt(46)
    v_lshlrev_b32 v10, 16, v25
    v_and_b32 v11, 0xffff0000, v25
    v_fmac_f32 v8, s60, v10
    v_fmac_f32 v9, s60, v11
    v_readlane_b32 s60, v6, 10
    s_waitcnt vmcnt(45)
    v_lshlrev_b32 v10, 16, v26
    v_and_b32 v11, 0xffff0000, v26
    v_fmac_f32 v8, s60, v10
    v_fmac_f32 v9, s60, v11
    v_readlane_b32 s60, v6, 11
    s_waitcnt vmcnt(44)
    v_lshlrev_b32 v10, 16, v27
    v_and_b32 v11, 0xffff0000, v27
    v_fmac_f32 v8, s60, v10
    v_fmac_f32 v9, s60, v11
    v_readlane_b32 s60, v6, 12
    s_waitcnt vmcnt(43)
    v_lshlrev_b32 v10, 16, v28
    v_and_b32 v11, 0xffff0000, v28
    v_fmac_f32 v8, s60, v10
    v_fmac_f32 v9, s60, v11
    v_readlane_b32 s60, v6, 13
    s_waitcnt vmcnt(42)
    v_lshlrev_b32 v10, 16, v29
    v_and_b32 v11, 0xffff0000, v29
    v_fmac_f32 v8, s60, v10
    v_fmac_f32 v9, s60, v11
    v_readlane_b32 s60, v6, 14
    s_waitcnt vmcnt(41)
    v_lshlrev_b32 v10, 16, v30
    v_and_b32 v11, 0xffff0000, v30
    v_fmac_f32 v8, s60, v10
    v_fmac_f32 v9, s60, v11
    v_readlane_b32 s60, v6, 15
    s_waitcnt vmcnt(40)
    v_lshlrev_b32 v10, 16, v31
    v_and_b32 v11, 0xffff0000, v31
    v_fmac_f32 v8, s60, v10
    v_fmac_f32 v9, s60, v11
    v_readlane_b32 s60, v6, 16
    s_waitcnt vmcnt(39)
    v_lshlrev_b32 v10, 16, v32
    v_and_b32 v11, 0xffff0000, v32
    v_fmac_f32 v8, s60, v10
    v_fmac_f32 v9, s60, v11
    v_readlane_b32 s60, v6, 17
    s_waitcnt vmcnt(38)
    v_lshlrev_b32 v10, 16, v33
    v_and_b32 v11, 0xffff0000, v33
    v_fmac_f32 v8, s60, v10
    v_fmac_f32 v9, s60, v11
    v_readlane_b32 s60, v6, 18
    s_waitcnt vmcnt(37)
    v_lshlrev_b32 v10, 16, v34
    v_and_b32 v11, 0xffff0000, v34
    v_fmac_f32 v8, s60, v10
    v_fmac_f32 v9, s60, v11
    v_readlane_b32 s60, v6, 19
    s_waitcnt vmcnt(36)
    v_lshlrev_b32 v10, 16, v35
    v_and_b32 v11, 0xffff0000, v35
    v_fmac_f32 v8, s60, v10
    v_fmac_f32 v9, s60, v11
    v_readlane_b32 s60, v6, 20
    s_waitcnt vmcnt(35)
    v_lshlrev_b32 v10, 16, v36
    v_and_b32 v11, 0xffff0000, v36
    v_fmac_f32 v8, s60, v10
    v_fmac_f32 v9, s60, v11
    v_readlane_b32 s60, v6, 21
    s_waitcnt vmcnt(34)
    v_lshlrev_b32 v10, 16, v37
    v_and_b32 v11, 0xffff0000, v37
    v_fmac_f32 v8, s60, v10
    v_fmac_f32 v9, s60, v11
    v_readlane_b32 s60, v6, 22
    s_waitcnt vmcnt(33)
    v_lshlrev_b32 v10, 16, v38
    v_and_b32 v11, 0xffff0000, v38
    v_fmac_f32 v8, s60, v10
    v_fmac_f32 v9, s60, v11
    v_readlane_b32 s60, v6, 23
    s_waitcnt vmcnt(32)
    v_lshlrev_b32 v10, 16, v39
    v_and_b32 v11, 0xffff0000, v39
    v_fmac_f32 v8, s60, v10
    v_fmac_f32 v9, s60, v11
    v_readlane_b32 s60, v6, 24
    s_waitcnt vmcnt(31)
    v_lshlrev_b32 v10, 16, v40
    v_and_b32 v11, 0xffff0000, v40
    v_fmac_f32 v8, s60, v10
    v_fmac_f32 v9, s60, v11
    v_readlane_b32 s60, v6, 25
    s_waitcnt vmcnt(30)
    v_lshlrev_b32 v10, 16, v41
    v_and_b32 v11, 0xffff0000, v41
    v_fmac_f32 v8, s60, v10
    v_fmac_f32 v9, s60, v11
    v_readlane_b32 s60, v6, 26
    s_waitcnt vmcnt(29)
    v_lshlrev_b32 v10, 16, v42
    v_and_b32 v11, 0xffff0000, v42
    v_fmac_f32 v8, s60, v10
    v_fmac_f32 v9, s60, v11
    v_readlane_b32 s60, v6, 27
    s_waitcnt vmcnt(28)
    v_lshlrev_b32 v10, 16, v43
    v_and_b32 v11, 0xffff0000, v43
    v_fmac_f32 v8, s60, v10
    v_fmac_f32 v9, s60, v11
    v_readlane_b32 s60, v6, 28
    s_waitcnt vmcnt(27)
    v_lshlrev_b32 v10, 16, v44
    v_and_b32 v11, 0xffff0000, v44
    v_fmac_f32 v8, s60, v10
    v_fmac_f32 v9, s60, v11
    v_readlane_b32 s60, v6, 29
    s_waitcnt vmcnt(26)
    v_lshlrev_b32 v10, 16, v45
    v_and_b32 v11, 0xffff0000, v45
    v_fmac_f32 v8, s60, v10
    v_fmac_f32 v9, s60, v11
    v_readlane_b32 s60, v6, 30
    s_waitcnt vmcnt(25)
    v_lshlrev_b32 v10, 16, v46
    v_and_b32 v11, 0xffff0000, v46
    v_fmac_f32 v8, s60, v10
    v_fmac_f32 v9, s60, v11
    v_readlane_b32 s60, v6, 31
    s_waitcnt vmcnt(24)
    v_lshlrev_b32 v10, 16, v47
    v_and_b32 v11, 0xffff0000, v47
    v_fmac_f32 v8, s60, v10
    v_fmac_f32 v9, s60, v11
    v_readlane_b32 s60, v6, 32
    s_waitcnt vmcnt(23)
    v_lshlrev_b32 v10, 16, v48
    v_and_b32 v11, 0xffff0000, v48
    v_fmac_f32 v8, s60, v10
    v_fmac_f32 v9, s60, v11
    v_readlane_b32 s60, v6, 33
    s_waitcnt vmcnt(22)
    v_lshlrev_b32 v10, 16, v49
    v_and_b32 v11, 0xffff0000, v49
    v_fmac_f32 v8, s60, v10
    v_fmac_f32 v9, s60, v11
    v_readlane_b32 s60, v6, 34
    s_waitcnt vmcnt(21)
    v_lshlrev_b32 v10, 16, v50
    v_and_b32 v11, 0xffff0000, v50
    v_fmac_f32 v8, s60, v10
    v_fmac_f32 v9, s60, v11
    v_readlane_b32 s60, v6, 35
    s_waitcnt vmcnt(20)
    v_lshlrev_b32 v10, 16, v51
    v_and_b32 v11, 0xffff0000, v51
    v_fmac_f32 v8, s60, v10
    v_fmac_f32 v9, s60, v11
    v_readlane_b32 s60, v6, 36
    s_waitcnt vmcnt(19)
    v_lshlrev_b32 v10, 16, v52
    v_and_b32 v11, 0xffff0000, v52
    v_fmac_f32 v8, s60, v10
    v_fmac_f32 v9, s60, v11
    v_readlane_b32 s60, v6, 37
    s_waitcnt vmcnt(18)
    v_lshlrev_b32 v10, 16, v53
    v_and_b32 v11, 0xffff0000, v53
    v_fmac_f32 v8, s60, v10
    v_fmac_f32 v9, s60, v11
    v_readlane_b32 s60, v6, 38
    s_waitcnt vmcnt(17)
    v_lshlrev_b32 v10, 16, v54
    v_and_b32 v11, 0xffff0000, v54
    v_fmac_f32 v8, s60, v10
    v_fmac_f32 v9, s60, v11
    v_readlane_b32 s60, v6, 39
    s_waitcnt vmcnt(16)
    v_lshlrev_b32 v10, 16, v55
    v_and_b32 v11, 0xffff0000, v55
    v_fmac_f32 v8, s60, v10
    v_fmac_f32 v9, s60, v11
    v_readlane_b32 s60, v6, 40
    s_waitcnt vmcnt(15)
    v_lshlrev_b32 v10, 16, v56
    v_and_b32 v11, 0xffff0000, v56
    v_fmac_f32 v8, s60, v10
    v_fmac_f32 v9, s60, v11
    v_readlane_b32 s60, v6, 41
    s_waitcnt vmcnt(14)
    v_lshlrev_b32 v10, 16, v57
    v_and_b32 v11, 0xffff0000, v57
    v_fmac_f32 v8, s60, v10
    v_fmac_f32 v9, s60, v11
    v_readlane_b32 s60, v6, 42
    s_waitcnt vmcnt(13)
    v_lshlrev_b32 v10, 16, v58
    v_and_b32 v11, 0xffff0000, v58
    v_fmac_f32 v8, s60, v10
    v_fmac_f32 v9, s60, v11
    v_readlane_b32 s60, v6, 43
    s_waitcnt vmcnt(12)
    v_lshlrev_b32 v10, 16, v59
    v_and_b32 v11, 0xffff0000, v59
    v_fmac_f32 v8, s60, v10
    v_fmac_f32 v9, s60, v11
    v_readlane_b32 s60, v6, 44
    s_waitcnt vmcnt(11)
    v_lshlrev_b32 v10, 16, v60
    v_and_b32 v11, 0xffff0000, v60
    v_fmac_f32 v8, s60, v10
    v_fmac_f32 v9, s60, v11
    v_readlane_b32 s60, v6, 45
    s_waitcnt vmcnt(10)
    v_lshlrev_b32 v10, 16, v61
    v_and_b32 v11, 0xffff0000, v61
    v_fmac_f32 v8, s60, v10
    v_fmac_f32 v9, s60, v11
    v_readlane_b32 s60, v6, 46
    s_waitcnt vmcnt(9)
    v_lshlrev_b32 v10, 16, v62
    v_and_b32 v11, 0xffff0000, v62
    v_fmac_f32 v8, s60, v10
    v_fmac_f32 v9, s60, v11
    v_readlane_b32 s60, v6, 47
    s_waitcnt vmcnt(8)
    v_lshlrev_b32 v10, 16, v63
    v_and_b32 v11, 0xffff0000, v63
    v_fmac_f32 v8, s60, v10
    v_fmac_f32 v9, s60, v11
    v_readlane_b32 s60, v6, 48
    s_waitcnt vmcnt(7)
    v_lshlrev_b32 v10, 16, v64
    v_and_b32 v11, 0xffff0000, v64
    v_fmac_f32 v8, s60, v10
    v_fmac_f32 v9, s60, v11
    v_readlane_b32 s60, v6, 49
    s_waitcnt vmcnt(6)
    v_lshlrev_b32 v10, 16, v65
    v_and_b32 v11, 0xffff0000, v65
    v_fmac_f32 v8, s60, v10
    v_fmac_f32 v9, s60, v11
    v_readlane_b32 s60, v6, 50
    s_waitcnt vmcnt(5)
    v_lshlrev_b32 v10, 16, v66
    v_and_b32 v11, 0xffff0000, v66
    v_fmac_f32 v8, s60, v10
    v_fmac_f32 v9, s60, v11
    v_readlane_b32 s60, v6, 51
    s_waitcnt vmcnt(4)
    v_lshlrev_b32 v10, 16, v67
    v_and_b32 v11, 0xffff0000, v67
    v_fmac_f32 v8, s60, v10
    v_fmac_f32 v9, s60, v11
    v_readlane_b32 s60, v6, 52
    s_waitcnt vmcnt(3)
    v_lshlrev_b32 v10, 16, v68
    v_and_b32 v11, 0xffff0000, v68
    v_fmac_f32 v8, s60, v10
    v_fmac_f32 v9, s60, v11
    v_readlane_b32 s60, v6, 53
    s_waitcnt vmcnt(2)
    v_lshlrev_b32 v10, 16, v69
    v_and_b32 v11, 0xffff0000, v69
    v_fmac_f32 v8, s60, v10
    v_fmac_f32 v9, s60, v11
    v_readlane_b32 s60, v6, 54
    s_waitcnt vmcnt(1)
    v_lshlrev_b32 v10, 16, v70
    v_and_b32 v11, 0xffff0000, v70
    v_fmac_f32 v8, s60, v10
    v_fmac_f32 v9, s60, v11
    v_readlane_b32 s60, v6, 55
    s_waitcnt vmcnt(0)
    v_lshlrev_b32 v10, 16, v71
    v_and_b32 v11, 0xffff0000, v71
    v_fmac_f32 v8, s60, v10
    v_fmac_f32 v9, s60, v11
    v_lshlrev_b32 v12, 3, v0
    ds_write_b64 v12, v[8:9]
    s_waitcnt lgkmcnt(0)
    s_barrier
    s_cmp_lg_u32 s56, 0
    s_cbranch_scc1 prep_kernel_end
    ds_read_b64 v[16:17], v12 offset:0
    ds_read_b64 v[18:19], v12 offset:512
    ds_read_b64 v[20:21], v12 offset:1024
    ds_read_b64 v[22:23], v12 offset:1536
    ds_read_b64 v[24:25], v12 offset:2048
    ds_read_b64 v[26:27], v12 offset:2560
    ds_read_b64 v[28:29], v12 offset:3072
    ds_read_b64 v[30:31], v12 offset:3584
    s_waitcnt lgkmcnt(0)
    v_add_f32 v16, v16, v18
    v_add_f32 v17, v17, v19
    v_add_f32 v16, v16, v20
    v_add_f32 v17, v17, v21
    v_add_f32 v16, v16, v22
    v_add_f32 v17, v17, v23
    v_add_f32 v16, v16, v24
    v_add_f32 v17, v17, v25
    v_add_f32 v16, v16, v26
    v_add_f32 v17, v17, v27
    v_add_f32 v16, v16, v28
    v_add_f32 v17, v17, v29
    v_add_f32 v16, v16, v30
    v_add_f32 v17, v17, v31
    s_lshl_b32 s58, s2, 7
    v_lshlrev_b32 v3, 1, v2
    v_add_u32 v3, s58, v3
    v_subrev_u32 v10, 448, v3
    v_cmp_gt_u32 vcc, 448, v10
    s_nop 1
    s_mov_b64 s[62:63], vcc
    v_subrev_u32 v11, 1792, v3
    v_cmp_gt_u32 vcc, 448, v11
    s_nop 1
    s_or_b64 vcc, vcc, s[62:63]
    v_add_f32 v18, 1.0, v16
    v_add_f32 v19, 1.0, v17
    s_nop 1
    v_cndmask_b32 v16, v16, v18, vcc
    v_cndmask_b32 v17, v17, v19, vcc
    v_lshlrev_b32 v3, 2, v3
    buffer_store_dwordx2 v[16:17], v3, s[48:51], 0 offen
prep_kernel_end:
    s_endpgm
.globl qkv_kernel
.p2align 8
.type qkv_kernel,@function
qkv_kernel:
    s_cmp_ge_u32 s2, 256
    s_cbranch_scc1 qkv_kernel_end
    s_load_dwordx16 s[16:31], s[0:1], 0
    s_load_dwordx4 s[32:35], s[0:1], 64
    s_load_dwordx2 s[36:37], s[0:1], 80
    v_lshrrev_b32 v1, 6, v0
    v_and_b32 v2, 63, v0
    v_readfirstlane_b32 s40, v1
    s_lshr_b32 s43, s2, 3
    s_bfe_u32 s41, s2, 0x20001
    s_lshl_b32 s41, s41, 3
    s_and_b32 s42, s43, 7
    s_add_u32 s41, s41, s42
    s_and_b32 s42, s2, 1
    s_lshl_b32 s42, s42, 2
    s_lshr_b32 s43, s43, 3
    s_add_u32 s42, s42, s43
    v_and_b32 v3, 7, v2
    v_lshrrev_b32 v4, 3, v2
    s_waitcnt lgkmcnt(0)
    s_mov_b32 s44, s16
    s_mov_b32 s45, s17
    s_mov_b32 s46, 0x1c0000
    s_mov_b32 s47, 0x20000
    s_mov_b32 s48, s36
    s_mov_b32 s49, s37
    s_mov_b32 s50, 0xe00
    s_mov_b32 s51, 0x20000
    s_add_u32 s52, s36, 0x10000
    s_addc_u32 s53, s37, 0
    s_mov_b32 s54, 0x150000
    s_mov_b32 s55, 0x20000
    s_lshl_b32 s60, s41, 6
    s_lshl_b32 s61, s40, 3
    s_add_u32 s60, s60, s61
    v_add_u32 v5, s60, v3
    v_mul_u32_u24 v5, 896, v5
    v_lshl_add_u32 v5, v4, 4, v5
    buffer_load_dwordx4 v[8:11], v5, s[44:47], 0 offen offset:0
    buffer_load_dwordx4 v[12:15], v5, s[44:47], 0 offen offset:128
    buffer_load_dwordx4 v[16:19], v5, s[44:47], 0 offen offset:256
    buffer_load_dwordx4 v[20:23], v5, s[44:47], 0 offen offset:384
    buffer_load_dwordx4 v[24:27], v5, s[44:47], 0 offen offset:512
    buffer_load_dwordx4 v[28:31], v5, s[44:47], 0 offen offset:640
    buffer_load_dwordx4 v[32:35], v5, s[44:47], 0 offen offset:768
    v_lshlrev_b32 v6, 4, v0
    buffer_load_dwordx4 v[36:39], v6, s[48:51], 0 offen
    v_lshlrev_b32 v7, 4, v2
    s_mul_i32 s62, s42, 6
    s_add_u32 s62, s62, s40
    s_mul_i32 s63, s62, 28672
    s_lshr_b32 s60, s40, 2
    s_mul_i32 s60, s60, 28672
    s_and_b32 s61, s40, 3
    s_lshl_b32 s61, s61, 7
    s_add_u32 s60, s60, s61
    s_barrier
    s_cmp_ge_u32 s40, 6
    s_cbranch_scc1 qkv_kernel_now
    buffer_load_dwordx4 v[128:131], v7, s[52:55], s63 offen offset:0
    buffer_load_dwordx4 v[132:135], v7, s[52:55], s63 offen offset:1024
    buffer_load_dwordx4 v[136:139], v7, s[52:55], s63 offen offset:2048
    buffer_load_dwordx4 v[140:143], v7, s[52:55], s63 offen offset:3072
    s_add_u32 s63, s63, 4096
    buffer_load_dwordx4 v[144:147], v7, s[52:55], s63 offen offset:0
    buffer_load_dwordx4 v[148:151], v7, s[52:55], s63 offen offset:1024
    buffer_load_dwordx4 v[152:155], v7, s[52:55], s63 offen offset:2048
    buffer_load_dwordx4 v[156:159], v7, s[52:55], s63 offen offset:3072
    s_add_u32 s63, s63, 4096
    s_waitcnt vmcnt(8)
    v_add_u32 v6, 57344, v6
    ds_write_b128 v6, v[36:39]
    v_lshlrev_b32 v40, 16, v8
    v_and_b32 v41, 0xffff0000, v8
    v_lshlrev_b32 v42, 16, v9
    v_and_b32 v43, 0xffff0000, v9
    v_lshlrev_b32 v44, 16, v10
    v_and_b32 v45, 0xffff0000, v10
    v_lshlrev_b32 v46, 16, v11
    v_and_b32 v47, 0xffff0000, v11
    v_lshlrev_b32 v48, 16, v12
    v_and_b32 v49, 0xffff0000, v12
    v_lshlrev_b32 v50, 16, v13
    v_and_b32 v51, 0xffff0000, v13
    v_lshlrev_b32 v52, 16, v14
    v_and_b32 v53, 0xffff0000, v14
    v_lshlrev_b32 v54, 16, v15
    v_and_b32 v55, 0xffff0000, v15
    buffer_load_dwordx4 v[160:163], v7, s[52:55], s63 offen offset:0
    v_lshlrev_b32 v56, 16, v16
    v_and_b32 v57, 0xffff0000, v16
    v_lshlrev_b32 v58, 16, v17
    v_and_b32 v59, 0xffff0000, v17
    v_lshlrev_b32 v60, 16, v18
    v_and_b32 v61, 0xffff0000, v18
    v_lshlrev_b32 v62, 16, v19
    v_and_b32 v63, 0xffff0000, v19
    v_lshlrev_b32 v64, 16, v20
    v_and_b32 v65, 0xffff0000, v20
    v_lshlrev_b32 v66, 16, v21
    v_and_b32 v67, 0xffff0000, v21
    v_lshlrev_b32 v68, 16, v22
    v_and_b32 v69, 0xffff0000, v22
    v_lshlrev_b32 v70, 16, v23
    v_and_b32 v71, 0xffff0000, v23
    v_lshlrev_b32 v72, 16, v24
    v_and_b32 v73, 0xffff0000, v24
    buffer_load_dwordx4 v[164:167], v7, s[52:55], s63 offen offset:1024
    v_lshlrev_b32 v74, 16, v25
    v_and_b32 v75, 0xffff0000, v25
    v_lshlrev_b32 v76, 16, v26
    v_and_b32 v77, 0xffff0000, v26
    v_lshlrev_b32 v78, 16, v27
    v_and_b32 v79, 0xffff0000, v27
    v_lshlrev_b32 v80, 16, v28
    v_and_b32 v81, 0xffff0000, v28
    v_lshlrev_b32 v82, 16, v29
    v_and_b32 v83, 0xffff0000, v29
    v_lshlrev_b32 v84, 16, v30
    v_and_b32 v85, 0xffff0000, v30
    v_lshlrev_b32 v86, 16, v31
    v_and_b32 v87, 0xffff0000, v31
    v_lshlrev_b32 v88, 16, v32
    v_and_b32 v89, 0xffff0000, v32
    v_lshlrev_b32 v90, 16, v33
    v_and_b32 v91, 0xffff0000, v33
    buffer_load_dwordx4 v[168:171], v7, s[52:55], s63 offen offset:2048
    v_lshlrev_b32 v92, 16, v34
    v_and_b32 v93, 0xffff0000, v34
    v_lshlrev_b32 v94, 16, v35
    v_and_b32 v95, 0xffff0000, v35
    v_pk_add_f32 v[96:97], v[40:41], v[42:43]
    v_pk_add_f32 v[98:99], v[44:45], v[46:47]
    v_pk_add_f32 v[96:97], v[96:97], v[48:49]
    v_pk_add_f32 v[98:99], v[98:99], v[50:51]
    v_pk_add_f32 v[96:97], v[96:97], v[52:53]
    v_pk_add_f32 v[98:99], v[98:99], v[54:55]
    v_pk_add_f32 v[96:97], v[96:97], v[56:57]
    v_pk_add_f32 v[98:99], v[98:99], v[58:59]
    v_pk_add_f32 v[96:97], v[96:97], v[60:61]
    v_pk_add_f32 v[98:99], v[98:99], v[62:63]
    v_pk_add_f32 v[96:97], v[96:97], v[64:65]
    v_pk_add_f32 v[98:99], v[98:99], v[66:67]
    v_pk_add_f32 v[96:97], v[96:97], v[68:69]
    v_pk_add_f32 v[98:99], v[98:99], v[70:71]
    buffer_load_dwordx4 v[172:175], v7, s[52:55], s63 offen offset:3072
    s_add_u32 s63, s63, 4096
    v_pk_add_f32 v[96:97], v[96:97], v[72:73]
    v_pk_add_f32 v[98:99], v[98:99], v[74:75]
    v_pk_add_f32 v[96:97], v[96:97], v[76:77]
    v_pk_add_f32 v[98:99], v[98:99], v[78:79]
    v_pk_add_f32 v[96:97], v[96:97], v[80:81]
    v_pk_add_f32 v[98:99], v[98:99], v[82:83]
    v_pk_add_f32 v[96:97], v[96:97], v[84:85]
    v_pk_add_f32 v[98:99], v[98:99], v[86:87]
    v_pk_add_f32 v[96:97], v[96:97], v[88:89]
    v_pk_add_f32 v[98:99], v[98:99], v[90:91]
    v_pk_add_f32 v[96:97], v[96:97], v[92:93]
    v_pk_add_f32 v[98:99], v[98:99], v[94:95]
    v_pk_add_f32 v[96:97], v[96:97], v[98:99]
    v_add_f32 v96, v96, v97
    s_nop 1
    v_add_f32_dpp v100, v96, v96 row_ror:8 row_mask:0xf bank_mask:0xf
    v_mov_b32 v101, v100
    s_nop 1
    buffer_load_dwordx4 v[176:179], v7, s[52:55], s63 offen offset:0
    v_permlane16_swap_b32 v100, v101
    s_nop 1
    v_add_f32 v100, v100, v101
    v_mov_b32 v101, v100
    s_nop 1
    v_permlane32_swap_b32 v100, v101
    s_nop 1
    v_add_f32 v96, v100, v101
    v_mul_f32 v96, 0xbb124925, v96
    v_mov_b32 v97, v96
    v_pk_add_f32 v[40:41], v[40:41], v[96:97]
    v_pk_add_f32 v[42:43], v[42:43], v[96:97]
    v_pk_add_f32 v[44:45], v[44:45], v[96:97]
    v_pk_add_f32 v[46:47], v[46:47], v[96:97]
    v_pk_add_f32 v[48:49], v[48:49], v[96:97]
    v_pk_add_f32 v[50:51], v[50:51], v[96:97]
    v_pk_add_f32 v[52:53], v[52:53], v[96:97]
    v_pk_add_f32 v[54:55], v[54:55], v[96:97]
    buffer_load_dwordx4 v[180:183], v7, s[52:55], s63 offen offset:1024
    v_pk_add_f32 v[56:57], v[56:57], v[96:97]
    v_pk_add_f32 v[58:59], v[58:59], v[96:97]
    v_pk_add_f32 v[60:61], v[60:61], v[96:97]
    v_pk_add_f32 v[62:63], v[62:63], v[96:97]
    v_pk_add_f32 v[64:65], v[64:65], v[96:97]
    v_pk_add_f32 v[66:67], v[66:67], v[96:97]
    v_pk_add_f32 v[68:69], v[68:69], v[96:97]
    v_pk_add_f32 v[70:71], v[70:71], v[96:97]
    v_pk_add_f32 v[72:73], v[72:73], v[96:97]
    v_pk_add_f32 v[74:75], v[74:75], v[96:97]
    v_pk_add_f32 v[76:77], v[76:77], v[96:97]
    v_pk_add_f32 v[78:79], v[78:79], v[96:97]
    v_pk_add_f32 v[80:81], v[80:81], v[96:97]
    v_pk_add_f32 v[82:83], v[82:83], v[96:97]
    v_pk_add_f32 v[84:85], v[84:85], v[96:97]
    v_pk_add_f32 v[86:87], v[86:87], v[96:97]
    v_pk_add_f32 v[88:89], v[88:89], v[96:97]
    v_pk_add_f32 v[90:91], v[90:91], v[96:97]
    buffer_load_dwordx4 v[184:187], v7, s[52:55], s63 offen offset:2048
    v_pk_add_f32 v[92:93], v[92:93], v[96:97]
    v_pk_add_f32 v[94:95], v[94:95], v[96:97]
    v_pk_mul_f32 v[98:99], v[40:41], v[40:41]
    v_pk_mul_f32 v[100:101], v[42:43], v[42:43]
    v_pk_fma_f32 v[98:99], v[44:45], v[44:45], v[98:99]
    v_pk_fma_f32 v[100:101], v[46:47], v[46:47], v[100:101]
    v_pk_fma_f32 v[98:99], v[48:49], v[48:49], v[98:99]
    v_pk_fma_f32 v[100:101], v[50:51], v[50:51], v[100:101]
    v_pk_fma_f32 v[98:99], v[52:53], v[52:53], v[98:99]
    v_pk_fma_f32 v[100:101], v[54:55], v[54:55], v[100:101]
    v_pk_fma_f32 v[98:99], v[56:57], v[56:57], v[98:99]
    v_pk_fma_f32 v[100:101], v[58:59], v[58:59], v[100:101]
    v_pk_fma_f32 v[98:99], v[60:61], v[60:61], v[98:99]
    v_pk_fma_f32 v[100:101], v[62:63], v[62:63], v[100:101]
    v_pk_fma_f32 v[98:99], v[64:65], v[64:65], v[98:99]
    v_pk_fma_f32 v[100:101], v[66:67], v[66:67], v[100:101]
    v_pk_fma_f32 v[98:99], v[68:69], v[68:69], v[98:99]
    v_pk_fma_f32 v[100:101], v[70:71], v[70:71], v[100:101]
    buffer_load_dwordx4 v[188:191], v7, s[52:55], s63 offen offset:3072
    s_add_u32 s63, s63, 4096
    v_pk_fma_f32 v[98:99], v[72:73], v[72:73], v[98:99]
    v_pk_fma_f32 v[100:101], v[74:75], v[74:75], v[100:101]
    v_pk_fma_f32 v[98:99], v[76:77], v[76:77], v[98:99]
    v_pk_fma_f32 v[100:101], v[78:79], v[78:79], v[100:101]
    v_pk_fma_f32 v[98:99], v[80:81], v[80:81], v[98:99]
    v_pk_fma_f32 v[100:101], v[82:83], v[82:83], v[100:101]
    v_pk_fma_f32 v[98:99], v[84:85], v[84:85], v[98:99]
    v_pk_fma_f32 v[100:101], v[86:87], v[86:87], v[100:101]
    v_pk_fma_f32 v[98:99], v[88:89], v[88:89], v[98:99]
    v_pk_fma_f32 v[100:101], v[90:91], v[90:91], v[100:101]
    v_pk_fma_f32 v[98:99], v[92:93], v[92:93], v[98:99]
    v_pk_fma_f32 v[100:101], v[94:95], v[94:95], v[100:101]
    v_pk_add_f32 v[98:99], v[98:99], v[100:101]
    v_add_f32 v97, v98, v99
    s_nop 1
    v_add_f32_dpp v100, v97, v97 row_ror:8 row_mask:0xf bank_mask:0xf
    v_mov_b32 v101, v100
    s_nop 1
    buffer_load_dwordx4 v[192:195], v7, s[52:55], s63 offen offset:0
    v_permlane16_swap_b32 v100, v101
    s_nop 1
    v_add_f32 v100, v100, v101
    v_mov_b32 v101, v100
    s_nop 1
    v_permlane32_swap_b32 v100, v101
    s_nop 1
    v_add_f32 v97, v100, v101
    v_mov_b32 v98, 0x3727c5ac
    v_fmac_f32 v98, 0x3b124925, v97
    v_rsq_f32 v98, v98
    v_lshlrev_b32 v5, 5, v4
    v_add_u32 v5, 57344, v5
    v_lshrrev_b32 v6, 1, v4
    v_lshlrev_b32 v6, 10, v6
    v_and_b32 v36, 1, v4
    v_lshl_add_u32 v6, v36, 9, v6
    v_lshl_add_u32 v6, v3, 4, v6
    buffer_load_dwordx4 v[196:199], v7, s[52:55], s63 offen offset:1024
    v_add_u32 v6, s60, v6
    v_mov_b32 v99, v98
    s_waitcnt lgkmcnt(0)
    s_barrier
    ds_read_b128 v[8:11], v5 offset:0
    ds_read_b128 v[12:15], v5 offset:16
    ds_read_b128 v[16:19], v5 offset:1792
    ds_read_b128 v[20:23], v5 offset:1808
    v_pk_mul_f32 v[40:41], v[40:41], v[98:99]
    v_pk_mul_f32 v[42:43], v[42:43], v[98:99]
    v_pk_mul_f32 v[44:45], v[44:45], v[98:99]
    v_pk_mul_f32 v[46:47], v[46:47], v[98:99]
    s_waitcnt lgkmcnt(0)
    ds_read_b128 v[24:27], v5 offset:256
    ds_read_b128 v[28:31], v5 offset:272
    ds_read_b128 v[32:35], v5 offset:2048
    ds_read_b128 v[36:39], v5 offset:2064
    v_pk_fma_f32 v[40:41], v[40:41], v[16:17], v[8:9]
    v_pk_fma_f32 v[42:43], v[42:43], v[18:19], v[10:11]
    v_pk_fma_f32 v[44:45], v[44:45], v[20:21], v[12:13]
    v_pk_fma_f32 v[46:47], v[46:47], v[22:23], v[14:15]
    buffer_load_dwordx4 v[200:203], v7, s[52:55], s63 offen offset:2048
    v_cvt_pk_bf16_f32 v100, v40, v41
    v_cvt_pk_bf16_f32 v101, v42, v43
    v_cvt_pk_bf16_f32 v102, v44, v45
    v_cvt_pk_bf16_f32 v103, v46, v47
    ds_write_b128 v6, v[100:103] offset:0
    v_pk_mul_f32 v[48:49], v[48:49], v[98:99]
    v_pk_mul_f32 v[50:51], v[50:51], v[98:99]
    v_pk_mul_f32 v[52:53], v[52:53], v[98:99]
    v_pk_mul_f32 v[54:55], v[54:55], v[98:99]
    s_waitcnt lgkmcnt(1)
    ds_read_b128 v[8:11], v5 offset:512
    ds_read_b128 v[12:15], v5 offset:528
    ds_read_b128 v[16:19], v5 offset:2304
    ds_read_b128 v[20:23], v5 offset:2320
    v_pk_fma_f32 v[48:49], v[48:49], v[32:33], v[24:25]
    v_pk_fma_f32 v[50:51], v[50:51], v[34:35], v[26:27]
    v_pk_fma_f32 v[52:53], v[52:53], v[36:37], v[28:29]
    v_pk_fma_f32 v[54:55], v[54:55], v[38:39], v[30:31]
    v_cvt_pk_bf16_f32 v104, v48, v49
    buffer_load_dwordx4 v[204:207], v7, s[52:55], s63 offen offset:3072
    s_add_u32 s63, s63, 4096
    v_cvt_pk_bf16_f32 v105, v50, v51
    v_cvt_pk_bf16_f32 v106, v52, v53
    v_cvt_pk_bf16_f32 v107, v54, v55
    ds_write_b128 v6, v[104:107] offset:4096
    v_pk_mul_f32 v[56:57], v[56:57], v[98:99]
    v_pk_mul_f32 v[58:59], v[58:59], v[98:99]
    v_pk_mul_f32 v[60:61], v[60:61], v[98:99]
    v_pk_mul_f32 v[62:63], v[62:63], v[98:99]
    s_waitcnt lgkmcnt(1)
    ds_read_b128 v[24:27], v5 offset:768
    ds_read_b128 v[28:31], v5 offset:784
    ds_read_b128 v[32:35], v5 offset:2560
    ds_read_b128 v[36:39], v5 offset:2576
    v_pk_fma_f32 v[56:57], v[56:57], v[16:17], v[8:9]
    v_pk_fma_f32 v[58:59], v[58:59], v[18:19], v[10:11]
    v_pk_fma_f32 v[60:61], v[60:61], v[20:21], v[12:13]
    v_pk_fma_f32 v[62:63], v[62:63], v[22:23], v[14:15]
    v_cvt_pk_bf16_f32 v100, v56, v57
    v_cvt_pk_bf16_f32 v101, v58, v59
    buffer_load_dwordx4 v[208:211], v7, s[52:55], s63 offen offset:0
    v_cvt_pk_bf16_f32 v102, v60, v61
    v_cvt_pk_bf16_f32 v103, v62, v63
    ds_write_b128 v6, v[100:103] offset:8192
    v_pk_mul_f32 v[64:65], v[64:65], v[98:99]
    v_pk_mul_f32 v[66:67], v[66:67], v[98:99]
    v_pk_mul_f32 v[68:69], v[68:69], v[98:99]
    v_pk_mul_f32 v[70:71], v[70:71], v[98:99]
    s_waitcnt lgkmcnt(1)
    ds_read_b128 v[8:11], v5 offset:1024
    ds_read_b128 v[12:15], v5 offset:1040
    ds_read_b128 v[16:19], v5 offset:2816
    ds_read_b128 v[20:23], v5 offset:2832
    v_pk_fma_f32 v[64:65], v[64:65], v[32:33], v[24:25]
    v_pk_fma_f32 v[66:67], v[66:67], v[34:35], v[26:27]
    v_pk_fma_f32 v[68:69], v[68:69], v[36:37], v[28:29]
    v_pk_fma_f32 v[70:71], v[70:71], v[38:39], v[30:31]
    v_cvt_pk_bf16_f32 v104, v64, v65
    v_cvt_pk_bf16_f32 v105, v66, v67
    v_cvt_pk_bf16_f32 v106, v68, v69
    buffer_load_dwordx4 v[212:215], v7, s[52:55], s63 offen offset:1024
    v_cvt_pk_bf16_f32 v107, v70, v71
    ds_write_b128 v6, v[104:107] offset:12288
    v_pk_mul_f32 v[72:73], v[72:73], v[98:99]
    v_pk_mul_f32 v[74:75], v[74:75], v[98:99]
    v_pk_mul_f32 v[76:77], v[76:77], v[98:99]
    v_pk_mul_f32 v[78:79], v[78:79], v[98:99]
    s_waitcnt lgkmcnt(1)
    ds_read_b128 v[24:27], v5 offset:1280
    ds_read_b128 v[28:31], v5 offset:1296
    ds_read_b128 v[32:35], v5 offset:3072
    ds_read_b128 v[36:39], v5 offset:3088
    v_pk_fma_f32 v[72:73], v[72:73], v[16:17], v[8:9]
    v_pk_fma_f32 v[74:75], v[74:75], v[18:19], v[10:11]
    v_pk_fma_f32 v[76:77], v[76:77], v[20:21], v[12:13]
    v_pk_fma_f32 v[78:79], v[78:79], v[22:23], v[14:15]
    v_cvt_pk_bf16_f32 v100, v72, v73
    v_cvt_pk_bf16_f32 v101, v74, v75
    v_cvt_pk_bf16_f32 v102, v76, v77
    v_cvt_pk_bf16_f32 v103, v78, v79
    buffer_load_dwordx4 v[216:219], v7, s[52:55], s63 offen offset:2048
    ds_write_b128 v6, v[100:103] offset:16384
    v_pk_mul_f32 v[80:81], v[80:81], v[98:99]
    v_pk_mul_f32 v[82:83], v[82:83], v[98:99]
    v_pk_mul_f32 v[84:85], v[84:85], v[98:99]
    v_pk_mul_f32 v[86:87], v[86:87], v[98:99]
    s_waitcnt lgkmcnt(1)
    ds_read_b128 v[8:11], v5 offset:1536
    ds_read_b128 v[12:15], v5 offset:1552
    ds_read_b128 v[16:19], v5 offset:3328
    ds_read_b128 v[20:23], v5 offset:3344
    v_pk_fma_f32 v[80:81], v[80:81], v[32:33], v[24:25]
    v_pk_fma_f32 v[82:83], v[82:83], v[34:35], v[26:27]
    v_pk_fma_f32 v[84:85], v[84:85], v[36:37], v[28:29]
    v_pk_fma_f32 v[86:87], v[86:87], v[38:39], v[30:31]
    v_cvt_pk_bf16_f32 v104, v80, v81
    v_cvt_pk_bf16_f32 v105, v82, v83
    v_cvt_pk_bf16_f32 v106, v84, v85
    v_cvt_pk_bf16_f32 v107, v86, v87
    ds_write_b128 v6, v[104:107] offset:20480
    buffer_load_dwordx4 v[220:223], v7, s[52:55], s63 offen offset:3072
    s_add_u32 s63, s63, 4096
    v_pk_mul_f32 v[88:89], v[88:89], v[98:99]
    v_pk_mul_f32 v[90:91], v[90:91], v[98:99]
    v_pk_mul_f32 v[92:93], v[92:93], v[98:99]
    v_pk_mul_f32 v[94:95], v[94:95], v[98:99]
    s_waitcnt lgkmcnt(0)
    v_pk_fma_f32 v[88:89], v[88:89], v[16:17], v[8:9]
    v_pk_fma_f32 v[90:91], v[90:91], v[18:19], v[10:11]
    v_pk_fma_f32 v[92:93], v[92:93], v[20:21], v[12:13]
    v_pk_fma_f32 v[94:95], v[94:95], v[22:23], v[14:15]
    v_cvt_pk_bf16_f32 v100, v88, v89
    v_cvt_pk_bf16_f32 v101, v90, v91
    v_cvt_pk_bf16_f32 v102, v92, v93
    v_cvt_pk_bf16_f32 v103, v94, v95
    ds_write_b128 v6, v[100:103] offset:24576
    buffer_load_dwordx4 v[224:227], v7, s[52:55], s63 offen offset:0
    buffer_load_dwordx4 v[228:231], v7, s[52:55], s63 offen offset:1024
    buffer_load_dwordx4 v[232:235], v7, s[52:55], s63 offen offset:2048
    buffer_load_dwordx4 v[236:239], v7, s[52:55], s63 offen offset:3072
    s_add_u32 s63, s63, 4096
    s_waitcnt lgkmcnt(0)
    s_barrier
    s_branch qkv_kernel_gemm
qkv_kernel_now:
    s_waitcnt vmcnt(0)
    v_add_u32 v6, 57344, v6
    ds_write_b128 v6, v[36:39]
    v_lshlrev_b32 v40, 16, v8
    v_and_b32 v41, 0xffff0000, v8
    v_lshlrev_b32 v42, 16, v9
    v_and_b32 v43, 0xffff0000, v9
    v_lshlrev_b32 v44, 16, v10
    v_and_b32 v45, 0xffff0000, v10
    v_lshlrev_b32 v46, 16, v11
    v_and_b32 v47, 0xffff0000, v11
    v_lshlrev_b32 v48, 16, v12
    v_and_b32 v49, 0xffff0000, v12
    v_lshlrev_b32 v50, 16, v13
    v_and_b32 v51, 0xffff0000, v13
    v_lshlrev_b32 v52, 16, v14
    v_and_b32 v53, 0xffff0000, v14
    v_lshlrev_b32 v54, 16, v15
    v_and_b32 v55, 0xffff0000, v15
    v_lshlrev_b32 v56, 16, v16
    v_and_b32 v57, 0xffff0000, v16
    v_lshlrev_b32 v58, 16, v17
    v_and_b32 v59, 0xffff0000, v17
    v_lshlrev_b32 v60, 16, v18
    v_and_b32 v61, 0xffff0000, v18
    v_lshlrev_b32 v62, 16, v19
    v_and_b32 v63, 0xffff0000, v19
    v_lshlrev_b32 v64, 16, v20
    v_and_b32 v65, 0xffff0000, v20
    v_lshlrev_b32 v66, 16, v21
    v_and_b32 v67, 0xffff0000, v21
    v_lshlrev_b32 v68, 16, v22
    v_and_b32 v69, 0xffff0000, v22
    v_lshlrev_b32 v70, 16, v23
    v_and_b32 v71, 0xffff0000, v23
    v_lshlrev_b32 v72, 16, v24
    v_and_b32 v73, 0xffff0000, v24
    v_lshlrev_b32 v74, 16, v25
    v_and_b32 v75, 0xffff0000, v25
    v_lshlrev_b32 v76, 16, v26
    v_and_b32 v77, 0xffff0000, v26
    v_lshlrev_b32 v78, 16, v27
    v_and_b32 v79, 0xffff0000, v27
    v_lshlrev_b32 v80, 16, v28
    v_and_b32 v81, 0xffff0000, v28
    v_lshlrev_b32 v82, 16, v29
    v_and_b32 v83, 0xffff0000, v29
    v_lshlrev_b32 v84, 16, v30
    v_and_b32 v85, 0xffff0000, v30
    v_lshlrev_b32 v86, 16, v31
    v_and_b32 v87, 0xffff0000, v31
    v_lshlrev_b32 v88, 16, v32
    v_and_b32 v89, 0xffff0000, v32
    v_lshlrev_b32 v90, 16, v33
    v_and_b32 v91, 0xffff0000, v33
    v_lshlrev_b32 v92, 16, v34
    v_and_b32 v93, 0xffff0000, v34
    v_lshlrev_b32 v94, 16, v35
    v_and_b32 v95, 0xffff0000, v35
    v_pk_add_f32 v[96:97], v[40:41], v[42:43]
    v_pk_add_f32 v[98:99], v[44:45], v[46:47]
    v_pk_add_f32 v[96:97], v[96:97], v[48:49]
    v_pk_add_f32 v[98:99], v[98:99], v[50:51]
    v_pk_add_f32 v[96:97], v[96:97], v[52:53]
    v_pk_add_f32 v[98:99], v[98:99], v[54:55]
    v_pk_add_f32 v[96:97], v[96:97], v[56:57]
    v_pk_add_f32 v[98:99], v[98:99], v[58:59]
    v_pk_add_f32 v[96:97], v[96:97], v[60:61]
    v_pk_add_f32 v[98:99], v[98:99], v[62:63]
    v_pk_add_f32 v[96:97], v[96:97], v[64:65]
    v_pk_add_f32 v[98:99], v[98:99], v[66:67]
    v_pk_add_f32 v[96:97], v[96:97], v[68:69]
    v_pk_add_f32 v[98:99], v[98:99], v[70:71]
    v_pk_add_f32 v[96:97], v[96:97], v[72:73]
    v_pk_add_f32 v[98:99], v[98:99], v[74:75]
    v_pk_add_f32 v[96:97], v[96:97], v[76:77]
    v_pk_add_f32 v[98:99], v[98:99], v[78:79]
    v_pk_add_f32 v[96:97], v[96:97], v[80:81]
    v_pk_add_f32 v[98:99], v[98:99], v[82:83]
    v_pk_add_f32 v[96:97], v[96:97], v[84:85]
    v_pk_add_f32 v[98:99], v[98:99], v[86:87]
    v_pk_add_f32 v[96:97], v[96:97], v[88:89]
    v_pk_add_f32 v[98:99], v[98:99], v[90:91]
    v_pk_add_f32 v[96:97], v[96:97], v[92:93]
    v_pk_add_f32 v[98:99], v[98:99], v[94:95]
    v_pk_add_f32 v[96:97], v[96:97], v[98:99]
    v_add_f32 v96, v96, v97
    s_nop 1
    v_add_f32_dpp v100, v96, v96 row_ror:8 row_mask:0xf bank_mask:0xf
    v_mov_b32 v101, v100
    s_nop 1
    v_permlane16_swap_b32 v100, v101
    s_nop 1
    v_add_f32 v100, v100, v101
    v_mov_b32 v101, v100
    s_nop 1
    v_permlane32_swap_b32 v100, v101
    s_nop 1
    v_add_f32 v96, v100, v101
    v_mul_f32 v96, 0xbb124925, v96
    v_mov_b32 v97, v96
    v_pk_add_f32 v[40:41], v[40:41], v[96:97]
    v_pk_add_f32 v[42:43], v[42:43], v[96:97]
    v_pk_add_f32 v[44:45], v[44:45], v[96:97]
    v_pk_add_f32 v[46:47], v[46:47], v[96:97]
    v_pk_add_f32 v[48:49], v[48:49], v[96:97]
    v_pk_add_f32 v[50:51], v[50:51], v[96:97]
    v_pk_add_f32 v[52:53], v[52:53], v[96:97]
    v_pk_add_f32 v[54:55], v[54:55], v[96:97]
    v_pk_add_f32 v[56:57], v[56:57], v[96:97]
    v_pk_add_f32 v[58:59], v[58:59], v[96:97]
    v_pk_add_f32 v[60:61], v[60:61], v[96:97]
    v_pk_add_f32 v[62:63], v[62:63], v[96:97]
    v_pk_add_f32 v[64:65], v[64:65], v[96:97]
    v_pk_add_f32 v[66:67], v[66:67], v[96:97]
    v_pk_add_f32 v[68:69], v[68:69], v[96:97]
    v_pk_add_f32 v[70:71], v[70:71], v[96:97]
    v_pk_add_f32 v[72:73], v[72:73], v[96:97]
    v_pk_add_f32 v[74:75], v[74:75], v[96:97]
    v_pk_add_f32 v[76:77], v[76:77], v[96:97]
    v_pk_add_f32 v[78:79], v[78:79], v[96:97]
    v_pk_add_f32 v[80:81], v[80:81], v[96:97]
    v_pk_add_f32 v[82:83], v[82:83], v[96:97]
    v_pk_add_f32 v[84:85], v[84:85], v[96:97]
    v_pk_add_f32 v[86:87], v[86:87], v[96:97]
    v_pk_add_f32 v[88:89], v[88:89], v[96:97]
    v_pk_add_f32 v[90:91], v[90:91], v[96:97]
    v_pk_add_f32 v[92:93], v[92:93], v[96:97]
    v_pk_add_f32 v[94:95], v[94:95], v[96:97]
    v_pk_mul_f32 v[98:99], v[40:41], v[40:41]
    v_pk_mul_f32 v[100:101], v[42:43], v[42:43]
    v_pk_fma_f32 v[98:99], v[44:45], v[44:45], v[98:99]
    v_pk_fma_f32 v[100:101], v[46:47], v[46:47], v[100:101]
    v_pk_fma_f32 v[98:99], v[48:49], v[48:49], v[98:99]
    v_pk_fma_f32 v[100:101], v[50:51], v[50:51], v[100:101]
    v_pk_fma_f32 v[98:99], v[52:53], v[52:53], v[98:99]
    v_pk_fma_f32 v[100:101], v[54:55], v[54:55], v[100:101]
    v_pk_fma_f32 v[98:99], v[56:57], v[56:57], v[98:99]
    v_pk_fma_f32 v[100:101], v[58:59], v[58:59], v[100:101]
    v_pk_fma_f32 v[98:99], v[60:61], v[60:61], v[98:99]
    v_pk_fma_f32 v[100:101], v[62:63], v[62:63], v[100:101]
    v_pk_fma_f32 v[98:99], v[64:65], v[64:65], v[98:99]
    v_pk_fma_f32 v[100:101], v[66:67], v[66:67], v[100:101]
    v_pk_fma_f32 v[98:99], v[68:69], v[68:69], v[98:99]
    v_pk_fma_f32 v[100:101], v[70:71], v[70:71], v[100:101]
    v_pk_fma_f32 v[98:99], v[72:73], v[72:73], v[98:99]
    v_pk_fma_f32 v[100:101], v[74:75], v[74:75], v[100:101]
    v_pk_fma_f32 v[98:99], v[76:77], v[76:77], v[98:99]
    v_pk_fma_f32 v[100:101], v[78:79], v[78:79], v[100:101]
    v_pk_fma_f32 v[98:99], v[80:81], v[80:81], v[98:99]
    v_pk_fma_f32 v[100:101], v[82:83], v[82:83], v[100:101]
    v_pk_fma_f32 v[98:99], v[84:85], v[84:85], v[98:99]
    v_pk_fma_f32 v[100:101], v[86:87], v[86:87], v[100:101]
    v_pk_fma_f32 v[98:99], v[88:89], v[88:89], v[98:99]
    v_pk_fma_f32 v[100:101], v[90:91], v[90:91], v[100:101]
    v_pk_fma_f32 v[98:99], v[92:93], v[92:93], v[98:99]
    v_pk_fma_f32 v[100:101], v[94:95], v[94:95], v[100:101]
    v_pk_add_f32 v[98:99], v[98:99], v[100:101]
    v_add_f32 v97, v98, v99
    s_nop 1
    v_add_f32_dpp v100, v97, v97 row_ror:8 row_mask:0xf bank_mask:0xf
    v_mov_b32 v101, v100
    s_nop 1
    v_permlane16_swap_b32 v100, v101
    s_nop 1
    v_add_f32 v100, v100, v101
    v_mov_b32 v101, v100
    s_nop 1
    v_permlane32_swap_b32 v100, v101
    s_nop 1
    v_add_f32 v97, v100, v101
    v_mov_b32 v98, 0x3727c5ac
    v_fmac_f32 v98, 0x3b124925, v97
    v_rsq_f32 v98, v98
    v_lshlrev_b32 v5, 5, v4
    v_add_u32 v5, 57344, v5
    v_lshrrev_b32 v6, 1, v4
    v_lshlrev_b32 v6, 10, v6
    v_and_b32 v36, 1, v4
    v_lshl_add_u32 v6, v36, 9, v6
    v_lshl_add_u32 v6, v3, 4, v6
    v_add_u32 v6, s60, v6
    v_mov_b32 v99, v98
    s_waitcnt lgkmcnt(0)
    s_barrier
    ds_read_b128 v[8:11], v5 offset:0
    ds_read_b128 v[12:15], v5 offset:16
    ds_read_b128 v[16:19], v5 offset:1792
    ds_read_b128 v[20:23], v5 offset:1808
    v_pk_mul_f32 v[40:41], v[40:41], v[98:99]
    v_pk_mul_f32 v[42:43], v[42:43], v[98:99]
    v_pk_mul_f32 v[44:45], v[44:45], v[98:99]
    v_pk_mul_f32 v[46:47], v[46:47], v[98:99]
    s_waitcnt lgkmcnt(0)
    ds_read_b128 v[24:27], v5 offset:256
    ds_read_b128 v[28:31], v5 offset:272
    ds_read_b128 v[32:35], v5 offset:2048
    ds_read_b128 v[36:39], v5 offset:2064
    v_pk_fma_f32 v[40:41], v[40:41], v[16:17], v[8:9]
    v_pk_fma_f32 v[42:43], v[42:43], v[18:19], v[10:11]
    v_pk_fma_f32 v[44:45], v[44:45], v[20:21], v[12:13]
    v_pk_fma_f32 v[46:47], v[46:47], v[22:23], v[14:15]
    v_cvt_pk_bf16_f32 v100, v40, v41
    v_cvt_pk_bf16_f32 v101, v42, v43
    v_cvt_pk_bf16_f32 v102, v44, v45
    v_cvt_pk_bf16_f32 v103, v46, v47
    ds_write_b128 v6, v[100:103] offset:0
    v_pk_mul_f32 v[48:49], v[48:49], v[98:99]
    v_pk_mul_f32 v[50:51], v[50:51], v[98:99]
    v_pk_mul_f32 v[52:53], v[52:53], v[98:99]
    v_pk_mul_f32 v[54:55], v[54:55], v[98:99]
    s_waitcnt lgkmcnt(1)
    ds_read_b128 v[8:11], v5 offset:512
    ds_read_b128 v[12:15], v5 offset:528
    ds_read_b128 v[16:19], v5 offset:2304
    ds_read_b128 v[20:23], v5 offset:2320
    v_pk_fma_f32 v[48:49], v[48:49], v[32:33], v[24:25]
    v_pk_fma_f32 v[50:51], v[50:51], v[34:35], v[26:27]
    v_pk_fma_f32 v[52:53], v[52:53], v[36:37], v[28:29]
    v_pk_fma_f32 v[54:55], v[54:55], v[38:39], v[30:31]
    v_cvt_pk_bf16_f32 v104, v48, v49
    v_cvt_pk_bf16_f32 v105, v50, v51
    v_cvt_pk_bf16_f32 v106, v52, v53
    v_cvt_pk_bf16_f32 v107, v54, v55
    ds_write_b128 v6, v[104:107] offset:4096
    v_pk_mul_f32 v[56:57], v[56:57], v[98:99]
    v_pk_mul_f32 v[58:59], v[58:59], v[98:99]
    v_pk_mul_f32 v[60:61], v[60:61], v[98:99]
    v_pk_mul_f32 v[62:63], v[62:63], v[98:99]
    s_waitcnt lgkmcnt(1)
    ds_read_b128 v[24:27], v5 offset:768
    ds_read_b128 v[28:31], v5 offset:784
    ds_read_b128 v[32:35], v5 offset:2560
    ds_read_b128 v[36:39], v5 offset:2576
    v_pk_fma_f32 v[56:57], v[56:57], v[16:17], v[8:9]
    v_pk_fma_f32 v[58:59], v[58:59], v[18:19], v[10:11]
    v_pk_fma_f32 v[60:61], v[60:61], v[20:21], v[12:13]
    v_pk_fma_f32 v[62:63], v[62:63], v[22:23], v[14:15]
    v_cvt_pk_bf16_f32 v100, v56, v57
    v_cvt_pk_bf16_f32 v101, v58, v59
    v_cvt_pk_bf16_f32 v102, v60, v61
    v_cvt_pk_bf16_f32 v103, v62, v63
    ds_write_b128 v6, v[100:103] offset:8192
    v_pk_mul_f32 v[64:65], v[64:65], v[98:99]
    v_pk_mul_f32 v[66:67], v[66:67], v[98:99]
    v_pk_mul_f32 v[68:69], v[68:69], v[98:99]
    v_pk_mul_f32 v[70:71], v[70:71], v[98:99]
    s_waitcnt lgkmcnt(1)
    ds_read_b128 v[8:11], v5 offset:1024
    ds_read_b128 v[12:15], v5 offset:1040
    ds_read_b128 v[16:19], v5 offset:2816
    ds_read_b128 v[20:23], v5 offset:2832
    v_pk_fma_f32 v[64:65], v[64:65], v[32:33], v[24:25]
    v_pk_fma_f32 v[66:67], v[66:67], v[34:35], v[26:27]
    v_pk_fma_f32 v[68:69], v[68:69], v[36:37], v[28:29]
    v_pk_fma_f32 v[70:71], v[70:71], v[38:39], v[30:31]
    v_cvt_pk_bf16_f32 v104, v64, v65
    v_cvt_pk_bf16_f32 v105, v66, v67
    v_cvt_pk_bf16_f32 v106, v68, v69
    v_cvt_pk_bf16_f32 v107, v70, v71
    ds_write_b128 v6, v[104:107] offset:12288
    v_pk_mul_f32 v[72:73], v[72:73], v[98:99]
    v_pk_mul_f32 v[74:75], v[74:75], v[98:99]
    v_pk_mul_f32 v[76:77], v[76:77], v[98:99]
    v_pk_mul_f32 v[78:79], v[78:79], v[98:99]
    s_waitcnt lgkmcnt(1)
    ds_read_b128 v[24:27], v5 offset:1280
    ds_read_b128 v[28:31], v5 offset:1296
    ds_read_b128 v[32:35], v5 offset:3072
    ds_read_b128 v[36:39], v5 offset:3088
    v_pk_fma_f32 v[72:73], v[72:73], v[16:17], v[8:9]
    v_pk_fma_f32 v[74:75], v[74:75], v[18:19], v[10:11]
    v_pk_fma_f32 v[76:77], v[76:77], v[20:21], v[12:13]
    v_pk_fma_f32 v[78:79], v[78:79], v[22:23], v[14:15]
    v_cvt_pk_bf16_f32 v100, v72, v73
    v_cvt_pk_bf16_f32 v101, v74, v75
    v_cvt_pk_bf16_f32 v102, v76, v77
    v_cvt_pk_bf16_f32 v103, v78, v79
    ds_write_b128 v6, v[100:103] offset:16384
    v_pk_mul_f32 v[80:81], v[80:81], v[98:99]
    v_pk_mul_f32 v[82:83], v[82:83], v[98:99]
    v_pk_mul_f32 v[84:85], v[84:85], v[98:99]
    v_pk_mul_f32 v[86:87], v[86:87], v[98:99]
    s_waitcnt lgkmcnt(1)
    ds_read_b128 v[8:11], v5 offset:1536
    ds_read_b128 v[12:15], v5 offset:1552
    ds_read_b128 v[16:19], v5 offset:3328
    ds_read_b128 v[20:23], v5 offset:3344
    v_pk_fma_f32 v[80:81], v[80:81], v[32:33], v[24:25]
    v_pk_fma_f32 v[82:83], v[82:83], v[34:35], v[26:27]
    v_pk_fma_f32 v[84:85], v[84:85], v[36:37], v[28:29]
    v_pk_fma_f32 v[86:87], v[86:87], v[38:39], v[30:31]
    v_cvt_pk_bf16_f32 v104, v80, v81
    v_cvt_pk_bf16_f32 v105, v82, v83
    v_cvt_pk_bf16_f32 v106, v84, v85
    v_cvt_pk_bf16_f32 v107, v86, v87
    ds_write_b128 v6, v[104:107] offset:20480
    v_pk_mul_f32 v[88:89], v[88:89], v[98:99]
    v_pk_mul_f32 v[90:91], v[90:91], v[98:99]
    v_pk_mul_f32 v[92:93], v[92:93], v[98:99]
    v_pk_mul_f32 v[94:95], v[94:95], v[98:99]
    s_waitcnt lgkmcnt(0)
    v_pk_fma_f32 v[88:89], v[88:89], v[16:17], v[8:9]
    v_pk_fma_f32 v[90:91], v[90:91], v[18:19], v[10:11]
    v_pk_fma_f32 v[92:93], v[92:93], v[20:21], v[12:13]
    v_pk_fma_f32 v[94:95], v[94:95], v[22:23], v[14:15]
    v_cvt_pk_bf16_f32 v100, v88, v89
    v_cvt_pk_bf16_f32 v101, v90, v91
    v_cvt_pk_bf16_f32 v102, v92, v93
    v_cvt_pk_bf16_f32 v103, v94, v95
    ds_write_b128 v6, v[100:103] offset:24576
    s_waitcnt lgkmcnt(0)
    s_barrier
    s_endpgm
qkv_kernel_gemm:
    s_add_u32 s56, s36, 0x4f0000
    s_addc_u32 s57, s37, 0
    s_mov_b32 s58, 0x600000
    s_mov_b32 s59, 0x20000
    s_lshl_b32 s64, s42, 1
    s_cmp_ge_u32 s40, 3
    s_cselect_b32 s65, 1, 0
    s_add_u32 s64, s64, s65
    s_mul_i32 s65, s65, 3
    s_sub_u32 s65, s40, s65
    s_mul_i32 s66, s65, 0x200000
    s_lshl_b32 s67, s64, 17
    s_add_u32 s66, s66, s67
    s_lshl_b32 s67, s41, 12
    s_add_u32 s66, s66, s67
    s_add_u32 s67, s66, 2048
    s_cmp_eq_u32 s65, 2
    s_cbranch_scc1 qkv_kernel_v
    ds_read_b128 v[40:43], v7 offset:0
    ds_read_b128 v[44:47], v7 offset:28672
    ds_read_b128 v[48:51], v7 offset:1024
    ds_read_b128 v[52:55], v7 offset:29696
    ds_read_b128 v[56:59], v7 offset:2048
    ds_read_b128 v[60:63], v7 offset:30720
    ds_read_b128 v[64:67], v7 offset:3072
    ds_read_b128 v[68:71], v7 offset:31744
    s_waitcnt lgkmcnt(6)
    s_waitcnt vmcnt(27)
    v_mfma_f32_32x32x16_bf16 v[8:23], v[128:131], v[40:43], 0
    v_mfma_f32_32x32x16_bf16 v[24:39], v[128:131], v[44:47], 0
    ds_read_b128 v[40:43], v7 offset:4096
    ds_read_b128 v[44:47], v7 offset:32768
    s_waitcnt lgkmcnt(6)
    s_waitcnt vmcnt(26)
    v_mfma_f32_32x32x16_bf16 v[8:23], v[132:135], v[48:51], v[8:23]
    v_mfma_f32_32x32x16_bf16 v[24:39], v[132:135], v[52:55], v[24:39]
    ds_read_b128 v[48:51], v7 offset:5120
    ds_read_b128 v[52:55], v7 offset:33792
    s_waitcnt lgkmcnt(6)
    s_waitcnt vmcnt(25)
    v_mfma_f32_32x32x16_bf16 v[8:23], v[136:139], v[56:59], v[8:23]
    v_mfma_f32_32x32x16_bf16 v[24:39], v[136:139], v[60:63], v[24:39]
    ds_read_b128 v[56:59], v7 offset:6144
    ds_read_b128 v[60:63], v7 offset:34816
    s_waitcnt lgkmcnt(6)
    s_waitcnt vmcnt(24)
    v_mfma_f32_32x32x16_bf16 v[8:23], v[140:143], v[64:67], v[8:23]
    v_mfma_f32_32x32x16_bf16 v[24:39], v[140:143], v[68:71], v[24:39]
    ds_read_b128 v[64:67], v7 offset:7168
    ds_read_b128 v[68:71], v7 offset:35840
    s_waitcnt lgkmcnt(6)
    s_waitcnt vmcnt(23)
    v_mfma_f32_32x32x16_bf16 v[8:23], v[144:147], v[40:43], v[8:23]
    v_mfma_f32_32x32x16_bf16 v[24:39], v[144:147], v[44:47], v[24:39]
    ds_read_b128 v[40:43], v7 offset:8192
    ds_read_b128 v[44:47], v7 offset:36864
    s_waitcnt lgkmcnt(6)
    s_waitcnt vmcnt(22)
    v_mfma_f32_32x32x16_bf16 v[8:23], v[148:151], v[48:51], v[8:23]
    v_mfma_f32_32x32x16_bf16 v[24:39], v[148:151], v[52:55], v[24:39]
    ds_read_b128 v[48:51], v7 offset:9216
    ds_read_b128 v[52:55], v7 offset:37888
    s_waitcnt lgkmcnt(6)
    s_waitcnt vmcnt(21)
    v_mfma_f32_32x32x16_bf16 v[8:23], v[152:155], v[56:59], v[8:23]
    v_mfma_f32_32x32x16_bf16 v[24:39], v[152:155], v[60:63], v[24:39]
    ds_read_b128 v[56:59], v7 offset:10240
    ds_read_b128 v[60:63], v7 offset:38912
    s_waitcnt lgkmcnt(6)
    s_waitcnt vmcnt(20)
    v_mfma_f32_32x32x16_bf16 v[8:23], v[156:159], v[64:67], v[8:23]
    v_mfma_f32_32x32x16_bf16 v[24:39], v[156:159], v[68:71], v[24:39]
    ds_read_b128 v[64:67], v7 offset:11264
    ds_read_b128 v[68:71], v7 offset:39936
    s_waitcnt lgkmcnt(6)
    s_waitcnt vmcnt(19)
    v_mfma_f32_32x32x16_bf16 v[8:23], v[160:163], v[40:43], v[8:23]
    v_mfma_f32_32x32x16_bf16 v[24:39], v[160:163], v[44:47], v[24:39]
    ds_read_b128 v[40:43], v7 offset:12288
    ds_read_b128 v[44:47], v7 offset:40960
    s_waitcnt lgkmcnt(6)
    s_waitcnt vmcnt(18)
    v_mfma_f32_32x32x16_bf16 v[8:23], v[164:167], v[48:51], v[8:23]
    v_mfma_f32_32x32x16_bf16 v[24:39], v[164:167], v[52:55], v[24:39]
    ds_read_b128 v[48:51], v7 offset:13312
    ds_read_b128 v[52:55], v7 offset:41984
    s_waitcnt lgkmcnt(6)
    s_waitcnt vmcnt(17)
    v_mfma_f32_32x32x16_bf16 v[8:23], v[168:171], v[56:59], v[8:23]
    v_mfma_f32_32x32x16_bf16 v[24:39], v[168:171], v[60:63], v[24:39]
    ds_read_b128 v[56:59], v7 offset:14336
    ds_read_b128 v[60:63], v7 offset:43008
    s_waitcnt lgkmcnt(6)
    s_waitcnt vmcnt(16)
    v_mfma_f32_32x32x16_bf16 v[8:23], v[172:175], v[64:67], v[8:23]
    v_mfma_f32_32x32x16_bf16 v[24:39], v[172:175], v[68:71], v[24:39]
    ds_read_b128 v[64:67], v7 offset:15360
    ds_read_b128 v[68:71], v7 offset:44032
    s_waitcnt lgkmcnt(6)
    s_waitcnt vmcnt(15)
    v_mfma_f32_32x32x16_bf16 v[8:23], v[176:179], v[40:43], v[8:23]
    v_mfma_f32_32x32x16_bf16 v[24:39], v[176:179], v[44:47], v[24:39]
    ds_read_b128 v[40:43], v7 offset:16384
    ds_read_b128 v[44:47], v7 offset:45056
    s_waitcnt lgkmcnt(6)
    s_waitcnt vmcnt(14)
    v_mfma_f32_32x32x16_bf16 v[8:23], v[180:183], v[48:51], v[8:23]
    v_mfma_f32_32x32x16_bf16 v[24:39], v[180:183], v[52:55], v[24:39]
    ds_read_b128 v[48:51], v7 offset:17408
    ds_read_b128 v[52:55], v7 offset:46080
    s_waitcnt lgkmcnt(6)
    s_waitcnt vmcnt(13)
    v_mfma_f32_32x32x16_bf16 v[8:23], v[184:187], v[56:59], v[8:23]
    v_mfma_f32_32x32x16_bf16 v[24:39], v[184:187], v[60:63], v[24:39]
    ds_read_b128 v[56:59], v7 offset:18432
    ds_read_b128 v[60:63], v7 offset:47104
    s_waitcnt lgkmcnt(6)
    s_waitcnt vmcnt(12)
    v_mfma_f32_32x32x16_bf16 v[8:23], v[188:191], v[64:67], v[8:23]
    v_mfma_f32_32x32x16_bf16 v[24:39], v[188:191], v[68:71], v[24:39]
    ds_read_b128 v[64:67], v7 offset:19456
    ds_read_b128 v[68:71], v7 offset:48128
    s_waitcnt lgkmcnt(6)
    s_waitcnt vmcnt(11)
    v_mfma_f32_32x32x16_bf16 v[8:23], v[192:195], v[40:43], v[8:23]
    v_mfma_f32_32x32x16_bf16 v[24:39], v[192:195], v[44:47], v[24:39]
    ds_read_b128 v[40:43], v7 offset:20480
    ds_read_b128 v[44:47], v7 offset:49152
    s_waitcnt lgkmcnt(6)
    s_waitcnt vmcnt(10)
    v_mfma_f32_32x32x16_bf16 v[8:23], v[196:199], v[48:51], v[8:23]
    v_mfma_f32_32x32x16_bf16 v[24:39], v[196:199], v[52:55], v[24:39]
    ds_read_b128 v[48:51], v7 offset:21504
    ds_read_b128 v[52:55], v7 offset:50176
    s_waitcnt lgkmcnt(6)
    s_waitcnt vmcnt(9)
    v_mfma_f32_32x32x16_bf16 v[8:23], v[200:203], v[56:59], v[8:23]
    v_mfma_f32_32x32x16_bf16 v[24:39], v[200:203], v[60:63], v[24:39]
    ds_read_b128 v[56:59], v7 offset:22528
    ds_read_b128 v[60:63], v7 offset:51200
    s_waitcnt lgkmcnt(6)
    s_waitcnt vmcnt(8)
    v_mfma_f32_32x32x16_bf16 v[8:23], v[204:207], v[64:67], v[8:23]
    v_mfma_f32_32x32x16_bf16 v[24:39], v[204:207], v[68:71], v[24:39]
    ds_read_b128 v[64:67], v7 offset:23552
    ds_read_b128 v[68:71], v7 offset:52224
    s_waitcnt lgkmcnt(6)
    s_waitcnt vmcnt(7)
    v_mfma_f32_32x32x16_bf16 v[8:23], v[208:211], v[40:43], v[8:23]
    v_mfma_f32_32x32x16_bf16 v[24:39], v[208:211], v[44:47], v[24:39]
    ds_read_b128 v[40:43], v7 offset:24576
    ds_read_b128 v[44:47], v7 offset:53248
    s_waitcnt lgkmcnt(6)
    s_waitcnt vmcnt(6)
    v_mfma_f32_32x32x16_bf16 v[8:23], v[212:215], v[48:51], v[8:23]
    v_mfma_f32_32x32x16_bf16 v[24:39], v[212:215], v[52:55], v[24:39]
    ds_read_b128 v[48:51], v7 offset:25600
    ds_read_b128 v[52:55], v7 offset:54272
    s_waitcnt lgkmcnt(6)
    s_waitcnt vmcnt(5)
    v_mfma_f32_32x32x16_bf16 v[8:23], v[216:219], v[56:59], v[8:23]
    v_mfma_f32_32x32x16_bf16 v[24:39], v[216:219], v[60:63], v[24:39]
    ds_read_b128 v[56:59], v7 offset:26624
    ds_read_b128 v[60:63], v7 offset:55296
    s_waitcnt lgkmcnt(6)
    s_waitcnt vmcnt(4)
    v_mfma_f32_32x32x16_bf16 v[8:23], v[220:223], v[64:67], v[8:23]
    v_mfma_f32_32x32x16_bf16 v[24:39], v[220:223], v[68:71], v[24:39]
    ds_read_b128 v[64:67], v7 offset:27648
    ds_read_b128 v[68:71], v7 offset:56320
    s_waitcnt lgkmcnt(6)
    s_waitcnt vmcnt(3)
    v_mfma_f32_32x32x16_bf16 v[8:23], v[224:227], v[40:43], v[8:23]
    v_mfma_f32_32x32x16_bf16 v[24:39], v[224:227], v[44:47], v[24:39]
    s_waitcnt lgkmcnt(4)
    s_waitcnt vmcnt(2)
    v_mfma_f32_32x32x16_bf16 v[8:23], v[228:231], v[48:51], v[8:23]
    v_mfma_f32_32x32x16_bf16 v[24:39], v[228:231], v[52:55], v[24:39]
    s_waitcnt lgkmcnt(2)
    s_waitcnt vmcnt(1)
    v_mfma_f32_32x32x16_bf16 v[8:23], v[232:235], v[56:59], v[8:23]
    v_mfma_f32_32x32x16_bf16 v[24:39], v[232:235], v[60:63], v[24:39]
    s_waitcnt lgkmcnt(0)
    s_waitcnt vmcnt(0)
    v_mfma_f32_32x32x16_bf16 v[8:23], v[236:239], v[64:67], v[8:23]
    v_mfma_f32_32x32x16_bf16 v[24:39], v[236:239], v[68:71], v[24:39]
    s_nop 15
    s_cmp_eq_u32 s65, 1
    s_cbranch_scc1 qkv_kernel_kst
    s_mov_b32 s68, 0x3e8b97f6
    v_mul_f32 v8, s68, v8
    v_mul_f32 v9, s68, v9
    v_mul_f32 v10, s68, v10
    v_mul_f32 v11, s68, v11
    v_mul_f32 v12, s68, v12
    v_mul_f32 v13, s68, v13
    v_mul_f32 v14, s68, v14
    v_mul_f32 v15, s68, v15
    v_mul_f32 v16, s68, v16
    v_mul_f32 v17, s68, v17
    v_mul_f32 v18, s68, v18
    v_mul_f32 v19, s68, v19
    v_mul_f32 v20, s68, v20
    v_mul_f32 v21, s68, v21
    v_mul_f32 v22, s68, v22
    v_mul_f32 v23, s68, v23
    v_mul_f32 v24, s68, v24
    v_mul_f32 v25, s68, v25
    v_mul_f32 v26, s68, v26
    v_mul_f32 v27, s68, v27
    v_mul_f32 v28, s68, v28
    v_mul_f32 v29, s68, v29
    v_mul_f32 v30, s68, v30
    v_mul_f32 v31, s68, v31
    v_mul_f32 v32, s68, v32
    v_mul_f32 v33, s68, v33
    v_mul_f32 v34, s68, v34
    v_mul_f32 v35, s68, v35
    v_mul_f32 v36, s68, v36
    v_mul_f32 v37, s68, v37
    v_mul_f32 v38, s68, v38
    v_mul_f32 v39, s68, v39
qkv_kernel_kst:
    v_cvt_pk_bf16_f32 v72, v8, v9
    v_cvt_pk_bf16_f32 v73, v10, v11
    v_cvt_pk_bf16_f32 v74, v12, v13
    v_cvt_pk_bf16_f32 v75, v14, v15
    v_cvt_pk_bf16_f32 v76, v16, v17
    v_cvt_pk_bf16_f32 v77, v18, v19
    v_cvt_pk_bf16_f32 v78, v20, v21
    v_cvt_pk_bf16_f32 v79, v22, v23
    buffer_store_dwordx4 v[72:75], v7, s[56:59], s66 offen sc1
    buffer_store_dwordx4 v[76:79], v7, s[56:59], s66 offen offset:1024 sc1
    s_nop 1
    v_cvt_pk_bf16_f32 v72, v24, v25
    v_cvt_pk_bf16_f32 v73, v26, v27
    v_cvt_pk_bf16_f32 v74, v28, v29
    v_cvt_pk_bf16_f32 v75, v30, v31
    v_cvt_pk_bf16_f32 v76, v32, v33
    v_cvt_pk_bf16_f32 v77, v34, v35
    v_cvt_pk_bf16_f32 v78, v36, v37
    v_cvt_pk_bf16_f32 v79, v38, v39
    buffer_store_dwordx4 v[72:75], v7, s[56:59], s67 offen sc1
    buffer_store_dwordx4 v[76:79], v7, s[56:59], s67 offen offset:1024 sc1
    s_nop 1
    s_endpgm
qkv_kernel_v:
    ds_read_b128 v[40:43], v7 offset:0
    ds_read_b128 v[44:47], v7 offset:28672
    ds_read_b128 v[48:51], v7 offset:1024
    ds_read_b128 v[52:55], v7 offset:29696
    ds_read_b128 v[56:59], v7 offset:2048
    ds_read_b128 v[60:63], v7 offset:30720
    ds_read_b128 v[64:67], v7 offset:3072
    ds_read_b128 v[68:71], v7 offset:31744
    s_waitcnt lgkmcnt(6)
    s_waitcnt vmcnt(27)
    v_mfma_f32_32x32x16_bf16 v[8:23], v[40:43], v[128:131], 0
    v_mfma_f32_32x32x16_bf16 v[24:39], v[44:47], v[128:131], 0
    ds_read_b128 v[40:43], v7 offset:4096
    ds_read_b128 v[44:47], v7 offset:32768
    s_waitcnt lgkmcnt(6)
    s_waitcnt vmcnt(26)
    v_mfma_f32_32x32x16_bf16 v[8:23], v[48:51], v[132:135], v[8:23]
    v_mfma_f32_32x32x16_bf16 v[24:39], v[52:55], v[132:135], v[24:39]
    ds_read_b128 v[48:51], v7 offset:5120
    ds_read_b128 v[52:55], v7 offset:33792
    s_waitcnt lgkmcnt(6)
    s_waitcnt vmcnt(25)
    v_mfma_f32_32x32x16_bf16 v[8:23], v[56:59], v[136:139], v[8:23]
    v_mfma_f32_32x32x16_bf16 v[24:39], v[60:63], v[136:139], v[24:39]
    ds_read_b128 v[56:59], v7 offset:6144
    ds_read_b128 v[60:63], v7 offset:34816
    s_waitcnt lgkmcnt(6)
    s_waitcnt vmcnt(24)
    v_mfma_f32_32x32x16_bf16 v[8:23], v[64:67], v[140:143], v[8:23]
    v_mfma_f32_32x32x16_bf16 v[24:39], v[68:71], v[140:143], v[24:39]
    ds_read_b128 v[64:67], v7 offset:7168
    ds_read_b128 v[68:71], v7 offset:35840
    s_waitcnt lgkmcnt(6)
    s_waitcnt vmcnt(23)
    v_mfma_f32_32x32x16_bf16 v[8:23], v[40:43], v[144:147], v[8:23]
    v_mfma_f32_32x32x16_bf16 v[24:39], v[44:47], v[144:147], v[24:39]
    ds_read_b128 v[40:43], v7 offset:8192
    ds_read_b128 v[44:47], v7 offset:36864
    s_waitcnt lgkmcnt(6)
    s_waitcnt vmcnt(22)
    v_mfma_f32_32x32x16_bf16 v[8:23], v[48:51], v[148:151], v[8:23]
    v_mfma_f32_32x32x16_bf16 v[24:39], v[52:55], v[148:151], v[24:39]
    ds_read_b128 v[48:51], v7 offset:9216
    ds_read_b128 v[52:55], v7 offset:37888
    s_waitcnt lgkmcnt(6)
    s_waitcnt vmcnt(21)
    v_mfma_f32_32x32x16_bf16 v[8:23], v[56:59], v[152:155], v[8:23]
    v_mfma_f32_32x32x16_bf16 v[24:39], v[60:63], v[152:155], v[24:39]
    ds_read_b128 v[56:59], v7 offset:10240
    ds_read_b128 v[60:63], v7 offset:38912
    s_waitcnt lgkmcnt(6)
    s_waitcnt vmcnt(20)
    v_mfma_f32_32x32x16_bf16 v[8:23], v[64:67], v[156:159], v[8:23]
    v_mfma_f32_32x32x16_bf16 v[24:39], v[68:71], v[156:159], v[24:39]
    ds_read_b128 v[64:67], v7 offset:11264
    ds_read_b128 v[68:71], v7 offset:39936
    s_waitcnt lgkmcnt(6)
    s_waitcnt vmcnt(19)
    v_mfma_f32_32x32x16_bf16 v[8:23], v[40:43], v[160:163], v[8:23]
    v_mfma_f32_32x32x16_bf16 v[24:39], v[44:47], v[160:163], v[24:39]
    ds_read_b128 v[40:43], v7 offset:12288
    ds_read_b128 v[44:47], v7 offset:40960
    s_waitcnt lgkmcnt(6)
    s_waitcnt vmcnt(18)
    v_mfma_f32_32x32x16_bf16 v[8:23], v[48:51], v[164:167], v[8:23]
    v_mfma_f32_32x32x16_bf16 v[24:39], v[52:55], v[164:167], v[24:39]
    ds_read_b128 v[48:51], v7 offset:13312
    ds_read_b128 v[52:55], v7 offset:41984
    s_waitcnt lgkmcnt(6)
    s_waitcnt vmcnt(17)
    v_mfma_f32_32x32x16_bf16 v[8:23], v[56:59], v[168:171], v[8:23]
    v_mfma_f32_32x32x16_bf16 v[24:39], v[60:63], v[168:171], v[24:39]
    ds_read_b128 v[56:59], v7 offset:14336
    ds_read_b128 v[60:63], v7 offset:43008
    s_waitcnt lgkmcnt(6)
    s_waitcnt vmcnt(16)
    v_mfma_f32_32x32x16_bf16 v[8:23], v[64:67], v[172:175], v[8:23]
    v_mfma_f32_32x32x16_bf16 v[24:39], v[68:71], v[172:175], v[24:39]
    ds_read_b128 v[64:67], v7 offset:15360
    ds_read_b128 v[68:71], v7 offset:44032
    s_waitcnt lgkmcnt(6)
    s_waitcnt vmcnt(15)
    v_mfma_f32_32x32x16_bf16 v[8:23], v[40:43], v[176:179], v[8:23]
    v_mfma_f32_32x32x16_bf16 v[24:39], v[44:47], v[176:179], v[24:39]
    ds_read_b128 v[40:43], v7 offset:16384
    ds_read_b128 v[44:47], v7 offset:45056
    s_waitcnt lgkmcnt(6)
    s_waitcnt vmcnt(14)
    v_mfma_f32_32x32x16_bf16 v[8:23], v[48:51], v[180:183], v[8:23]
    v_mfma_f32_32x32x16_bf16 v[24:39], v[52:55], v[180:183], v[24:39]
    ds_read_b128 v[48:51], v7 offset:17408
    ds_read_b128 v[52:55], v7 offset:46080
    s_waitcnt lgkmcnt(6)
    s_waitcnt vmcnt(13)
    v_mfma_f32_32x32x16_bf16 v[8:23], v[56:59], v[184:187], v[8:23]
    v_mfma_f32_32x32x16_bf16 v[24:39], v[60:63], v[184:187], v[24:39]
    ds_read_b128 v[56:59], v7 offset:18432
    ds_read_b128 v[60:63], v7 offset:47104
    s_waitcnt lgkmcnt(6)
    s_waitcnt vmcnt(12)
    v_mfma_f32_32x32x16_bf16 v[8:23], v[64:67], v[188:191], v[8:23]
    v_mfma_f32_32x32x16_bf16 v[24:39], v[68:71], v[188:191], v[24:39]
    ds_read_b128 v[64:67], v7 offset:19456
    ds_read_b128 v[68:71], v7 offset:48128
    s_waitcnt lgkmcnt(6)
    s_waitcnt vmcnt(11)
    v_mfma_f32_32x32x16_bf16 v[8:23], v[40:43], v[192:195], v[8:23]
    v_mfma_f32_32x32x16_bf16 v[24:39], v[44:47], v[192:195], v[24:39]
    ds_read_b128 v[40:43], v7 offset:20480
    ds_read_b128 v[44:47], v7 offset:49152
    s_waitcnt lgkmcnt(6)
    s_waitcnt vmcnt(10)
    v_mfma_f32_32x32x16_bf16 v[8:23], v[48:51], v[196:199], v[8:23]
    v_mfma_f32_32x32x16_bf16 v[24:39], v[52:55], v[196:199], v[24:39]
    ds_read_b128 v[48:51], v7 offset:21504
    ds_read_b128 v[52:55], v7 offset:50176
    s_waitcnt lgkmcnt(6)
    s_waitcnt vmcnt(9)
    v_mfma_f32_32x32x16_bf16 v[8:23], v[56:59], v[200:203], v[8:23]
    v_mfma_f32_32x32x16_bf16 v[24:39], v[60:63], v[200:203], v[24:39]
    ds_read_b128 v[56:59], v7 offset:22528
    ds_read_b128 v[60:63], v7 offset:51200
    s_waitcnt lgkmcnt(6)
    s_waitcnt vmcnt(8)
    v_mfma_f32_32x32x16_bf16 v[8:23], v[64:67], v[204:207], v[8:23]
    v_mfma_f32_32x32x16_bf16 v[24:39], v[68:71], v[204:207], v[24:39]
    ds_read_b128 v[64:67], v7 offset:23552
    ds_read_b128 v[68:71], v7 offset:52224
    s_waitcnt lgkmcnt(6)
    s_waitcnt vmcnt(7)
    v_mfma_f32_32x32x16_bf16 v[8:23], v[40:43], v[208:211], v[8:23]
    v_mfma_f32_32x32x16_bf16 v[24:39], v[44:47], v[208:211], v[24:39]
    ds_read_b128 v[40:43], v7 offset:24576
    ds_read_b128 v[44:47], v7 offset:53248
    s_waitcnt lgkmcnt(6)
    s_waitcnt vmcnt(6)
    v_mfma_f32_32x32x16_bf16 v[8:23], v[48:51], v[212:215], v[8:23]
    v_mfma_f32_32x32x16_bf16 v[24:39], v[52:55], v[212:215], v[24:39]
    ds_read_b128 v[48:51], v7 offset:25600
    ds_read_b128 v[52:55], v7 offset:54272
    s_waitcnt lgkmcnt(6)
    s_waitcnt vmcnt(5)
    v_mfma_f32_32x32x16_bf16 v[8:23], v[56:59], v[216:219], v[8:23]
    v_mfma_f32_32x32x16_bf16 v[24:39], v[60:63], v[216:219], v[24:39]
    ds_read_b128 v[56:59], v7 offset:26624
    ds_read_b128 v[60:63], v7 offset:55296
    s_waitcnt lgkmcnt(6)
    s_waitcnt vmcnt(4)
    v_mfma_f32_32x32x16_bf16 v[8:23], v[64:67], v[220:223], v[8:23]
    v_mfma_f32_32x32x16_bf16 v[24:39], v[68:71], v[220:223], v[24:39]
    ds_read_b128 v[64:67], v7 offset:27648
    ds_read_b128 v[68:71], v7 offset:56320
    s_waitcnt lgkmcnt(6)
    s_waitcnt vmcnt(3)
    v_mfma_f32_32x32x16_bf16 v[8:23], v[40:43], v[224:227], v[8:23]
    v_mfma_f32_32x32x16_bf16 v[24:39], v[44:47], v[224:227], v[24:39]
    s_waitcnt lgkmcnt(4)
    s_waitcnt vmcnt(2)
    v_mfma_f32_32x32x16_bf16 v[8:23], v[48:51], v[228:231], v[8:23]
    v_mfma_f32_32x32x16_bf16 v[24:39], v[52:55], v[228:231], v[24:39]
    s_waitcnt lgkmcnt(2)
    s_waitcnt vmcnt(1)
    v_mfma_f32_32x32x16_bf16 v[8:23], v[56:59], v[232:235], v[8:23]
    v_mfma_f32_32x32x16_bf16 v[24:39], v[60:63], v[232:235], v[24:39]
    s_waitcnt lgkmcnt(0)
    s_waitcnt vmcnt(0)
    v_mfma_f32_32x32x16_bf16 v[8:23], v[64:67], v[236:239], v[8:23]
    v_mfma_f32_32x32x16_bf16 v[24:39], v[68:71], v[236:239], v[24:39]
    s_nop 15
    v_and_b32 v80, 31, v2
    v_cmp_eq_u32 vcc, 28, v80
    v_mov_b32 v81, 1.0
    s_nop 1
    v_cndmask_b32 v8, v8, v81, vcc
    v_cndmask_b32 v9, v9, v81, vcc
    v_cndmask_b32 v10, v10, v81, vcc
    v_cndmask_b32 v11, v11, v81, vcc
    v_cndmask_b32 v12, v12, v81, vcc
    v_cndmask_b32 v13, v13, v81, vcc
    v_cndmask_b32 v14, v14, v81, vcc
    v_cndmask_b32 v15, v15, v81, vcc
    v_cndmask_b32 v16, v16, v81, vcc
    v_cndmask_b32 v17, v17, v81, vcc
    v_cndmask_b32 v18, v18, v81, vcc
    v_cndmask_b32 v19, v19, v81, vcc
    v_cndmask_b32 v20, v20, v81, vcc
    v_cndmask_b32 v21, v21, v81, vcc
    v_cndmask_b32 v22, v22, v81, vcc
    v_cndmask_b32 v23, v23, v81, vcc
    v_cndmask_b32 v24, v24, v81, vcc
    v_cndmask_b32 v25, v25, v81, vcc
    v_cndmask_b32 v26, v26, v81, vcc
    v_cndmask_b32 v27, v27, v81, vcc
    v_cndmask_b32 v28, v28, v81, vcc
    v_cndmask_b32 v29, v29, v81, vcc
    v_cndmask_b32 v30, v30, v81, vcc
    v_cndmask_b32 v31, v31, v81, vcc
    v_cndmask_b32 v32, v32, v81, vcc
    v_cndmask_b32 v33, v33, v81, vcc
    v_cndmask_b32 v34, v34, v81, vcc
    v_cndmask_b32 v35, v35, v81, vcc
    v_cndmask_b32 v36, v36, v81, vcc
    v_cndmask_b32 v37, v37, v81, vcc
    v_cndmask_b32 v38, v38, v81, vcc
    v_cndmask_b32 v39, v39, v81, vcc
    v_cvt_pk_bf16_f32 v72, v8, v9
    v_cvt_pk_bf16_f32 v73, v10, v11
    v_cvt_pk_bf16_f32 v74, v12, v13
    v_cvt_pk_bf16_f32 v75, v14, v15
    v_cvt_pk_bf16_f32 v76, v16, v17
    v_cvt_pk_bf16_f32 v77, v18, v19
    v_cvt_pk_bf16_f32 v78, v20, v21
    v_cvt_pk_bf16_f32 v79, v22, v23
    buffer_store_dwordx4 v[72:75], v7, s[56:59], s66 offen sc1
    buffer_store_dwordx4 v[76:79], v7, s[56:59], s66 offen offset:1024 sc1
    s_nop 1
    v_cvt_pk_bf16_f32 v72, v24, v25
    v_cvt_pk_bf16_f32 v73, v26, v27
    v_cvt_pk_bf16_f32 v74, v28, v29
    v_cvt_pk_bf16_f32 v75, v30, v31
    v_cvt_pk_bf16_f32 v76, v32, v33
    v_cvt_pk_bf16_f32 v77, v34, v35
    v_cvt_pk_bf16_f32 v78, v36, v37
    v_cvt_pk_bf16_f32 v79, v38, v39
    buffer_store_dwordx4 v[72:75], v7, s[56:59], s67 offen sc1
    buffer_store_dwordx4 v[76:79], v7, s[56:59], s67 offen offset:1024 sc1
    s_nop 1
qkv_kernel_end:
    s_endpgm
.globl attn_kernel
.p2align 8
.type attn_kernel,@function
attn_kernel:
    s_cmp_ge_u32 s2, 256
    s_cbranch_scc1 attn_kernel_end
    s_load_dwordx16 s[16:31], s[0:1], 0
    s_load_dwordx4 s[32:35], s[0:1], 64
    s_load_dwordx2 s[36:37], s[0:1], 80
    v_lshrrev_b32 v1, 6, v0
    v_and_b32 v2, 63, v0
    v_readfirstlane_b32 s40, v1
    s_and_b32 s41, s2, 15
    s_lshr_b32 s42, s2, 4
    v_lshlrev_b32 v3, 4, v2
    v_mov_b32 v4, 131072
    v_mov_b32 v5, 0
    ds_write_b32 v4, v5
    s_waitcnt lgkmcnt(0)
    s_add_u32 s44, s36, 0x4f0000
    s_addc_u32 s45, s37, 0
    s_mov_b32 s46, 0x200000
    s_mov_b32 s47, 0x20000
    s_add_u32 s48, s36, 0x6f0000
    s_addc_u32 s49, s37, 0
    s_mov_b32 s50, 0x200000
    s_mov_b32 s51, 0x20000
    s_add_u32 s52, s36, 0x8f0000
    s_addc_u32 s53, s37, 0
    s_mov_b32 s54, 0x200000
    s_mov_b32 s55, 0x20000
    s_add_u32 s56, s36, 0xaf0000
    s_addc_u32 s57, s37, 0
    s_mov_b32 s58, 0x200000
    s_mov_b32 s59, 0x20000
    s_lshl_b32 s60, s42, 2
    s_add_u32 s60, s60, s40
    s_lshl_b32 s61, s41, 6
    s_add_u32 s61, s61, s60
    s_lshl_b32 s61, s61, 11
    buffer_load_dwordx4 v[8:11], v3, s[44:47], s61 offen
    buffer_load_dwordx4 v[12:15], v3, s[44:47], s61 offen offset:1024
    s_lshl_b32 s63, s40, 11
    s_mul_i32 s69, s40, 4096
    s_lshl_b32 s70, s41, 17
    s_add_u32 s70, s70, s69
    s_add_u32 s71, s69, 0
    s_mov_b32 m0, s71
    s_add_u32 s72, s70, 0
    buffer_load_dwordx4 v3, s[48:51], s72 offen offset:0 lds
    buffer_load_dwordx4 v3, s[48:51], s72 offen offset:1024 lds
    buffer_load_dwordx4 v3, s[48:51], s72 offen offset:2048 lds
    buffer_load_dwordx4 v3, s[48:51], s72 offen offset:3072 lds
    s_add_u32 s71, s69, 16384
    s_mov_b32 m0, s71
    s_add_u32 s72, s70, 0
    buffer_load_dwordx4 v3, s[52:55], s72 offen offset:0 lds
    buffer_load_dwordx4 v3, s[52:55], s72 offen offset:1024 lds
    buffer_load_dwordx4 v3, s[52:55], s72 offen offset:2048 lds
    buffer_load_dwordx4 v3, s[52:55], s72 offen offset:3072 lds
    v_mov_b32 v16, 0
    v_mov_b32 v17, 0
    v_mov_b32 v18, 0
    v_mov_b32 v19, 0
    v_mov_b32 v20, 0
    v_mov_b32 v21, 0
    v_mov_b32 v22, 0
    v_mov_b32 v23, 0
    v_mov_b32 v24, 0
    v_mov_b32 v25, 0
    v_mov_b32 v26, 0
    v_mov_b32 v27, 0
    v_mov_b32 v28, 0
    v_mov_b32 v29, 0
    v_mov_b32 v30, 0
    v_mov_b32 v31, 0
    v_mov_b32 v72, 0
    v_mov_b32 v104, 0
    v_mov_b32 v73, 0
    v_mov_b32 v105, 0
    v_mov_b32 v74, 0
    v_mov_b32 v106, 0
    v_mov_b32 v75, 0
    v_mov_b32 v107, 0
    v_mov_b32 v76, 0
    v_mov_b32 v108, 0
    v_mov_b32 v77, 0
    v_mov_b32 v109, 0
    v_mov_b32 v78, 0
    v_mov_b32 v110, 0
    v_mov_b32 v79, 0
    v_mov_b32 v111, 0
    v_add_u32 v4, 0x10000, v3
    s_waitcnt vmcnt(0)
    s_barrier
    s_add_u32 s71, s69, 32768
    s_mov_b32 m0, s71
    s_add_u32 s72, s70, 16384
    buffer_load_dwordx4 v3, s[48:51], s72 offen offset:0 lds
    buffer_load_dwordx4 v3, s[48:51], s72 offen offset:1024 lds
    buffer_load_dwordx4 v3, s[48:51], s72 offen offset:2048 lds
    buffer_load_dwordx4 v3, s[48:51], s72 offen offset:3072 lds
    s_add_u32 s71, s69, 49152
    s_mov_b32 m0, s71
    s_add_u32 s72, s70, 16384
    buffer_load_dwordx4 v3, s[52:55], s72 offen offset:0 lds
    buffer_load_dwordx4 v3, s[52:55], s72 offen offset:1024 lds
    buffer_load_dwordx4 v3, s[52:55], s72 offen offset:2048 lds
    buffer_load_dwordx4 v3, s[52:55], s72 offen offset:3072 lds
    ds_read_b128 v[80:83], v3 offset:0
    ds_read_b128 v[84:87], v3 offset:1024
    ds_read_b128 v[88:91], v3 offset:2048
    ds_read_b128 v[92:95], v3 offset:3072
    s_waitcnt lgkmcnt(2)
    v_mfma_f32_32x32x16_bf16 v[32:47], v[80:83], v[8:11], 0
    v_mfma_f32_32x32x16_bf16 v[32:47], v[84:87], v[12:15], v[32:47]
    s_nop 15
    v_max3_f32 v6, v32, v33, v34
    v_max3_f32 v6, v6, v35, v36
    v_max3_f32 v6, v6, v37, v38
    v_max3_f32 v6, v6, v39, v40
    v_max3_f32 v6, v6, v41, v42
    v_max3_f32 v6, v6, v43, v44
    v_max3_f32 v6, v6, v45, v46
    v_max_f32 v6, v6, v47
    v_mov_b32 v7, v6
    s_nop 1
    v_permlane32_swap_b32 v6, v7
    s_nop 1
    v_max_f32 v6, v6, v7
    v_sub_f32 v112, 0, v6
    v_sub_f32 v113, 0, v6
    v_sub_f32 v114, 0, v6
    v_sub_f32 v115, 0, v6
    v_sub_f32 v116, 0, v6
    v_sub_f32 v117, 0, v6
    v_sub_f32 v118, 0, v6
    v_sub_f32 v119, 0, v6
    v_sub_f32 v120, 0, v6
    v_sub_f32 v121, 0, v6
    v_sub_f32 v122, 0, v6
    v_sub_f32 v123, 0, v6
    v_sub_f32 v124, 0, v6
    v_sub_f32 v125, 0, v6
    v_sub_f32 v126, 0, v6
    v_sub_f32 v127, 0, v6
    v_sub_f32 v32, v32, v6
    v_sub_f32 v33, v33, v6
    v_sub_f32 v34, v34, v6
    v_sub_f32 v35, v35, v6
    v_sub_f32 v36, v36, v6
    v_sub_f32 v37, v37, v6
    v_sub_f32 v38, v38, v6
    v_sub_f32 v39, v39, v6
    v_sub_f32 v40, v40, v6
    v_sub_f32 v41, v41, v6
    v_sub_f32 v42, v42, v6
    v_sub_f32 v43, v43, v6
    v_sub_f32 v44, v44, v6
    v_sub_f32 v45, v45, v6
    v_sub_f32 v46, v46, v6
    v_sub_f32 v47, v47, v6
    s_waitcnt lgkmcnt(0)
    v_mfma_f32_32x32x16_bf16 v[48:63], v[88:91], v[8:11], v[112:127]
    ds_read_b128 v[80:83], v3 offset:4096
    ds_read_b128 v[84:87], v3 offset:5120
    v_exp_f32 v32, v32
    v_exp_f32 v33, v33
    v_exp_f32 v34, v34
    v_exp_f32 v35, v35
    v_cvt_pk_bf16_f32 v64, v32, v33
    v_cvt_pk_bf16_f32 v65, v34, v35
    ds_read_b128 v[96:99], v3 offset:16384
    ds_read_b128 v[100:103], v3 offset:17408
    s_add_u32 s71, s69, 65536
    s_mov_b32 m0, s71
    s_add_u32 s72, s70, 32768
    buffer_load_dwordx4 v3, s[48:51], s72 offen offset:0 lds
    v_exp_f32 v36, v36
    v_exp_f32 v37, v37
    v_exp_f32 v38, v38
    v_exp_f32 v39, v39
    v_cvt_pk_bf16_f32 v66, v36, v37
    v_cvt_pk_bf16_f32 v67, v38, v39
    v_mfma_f32_32x32x16_bf16 v[48:63], v[92:95], v[12:15], v[48:63]
    buffer_load_dwordx4 v3, s[48:51], s72 offen offset:1024 lds
    v_exp_f32 v40, v40
    v_exp_f32 v41, v41
    v_exp_f32 v42, v42
    v_exp_f32 v43, v43
    v_cvt_pk_bf16_f32 v68, v40, v41
    v_cvt_pk_bf16_f32 v69, v42, v43
    v_exp_f32 v44, v44
    v_exp_f32 v45, v45
    v_exp_f32 v46, v46
    v_exp_f32 v47, v47
    v_cvt_pk_bf16_f32 v70, v44, v45
    v_cvt_pk_bf16_f32 v71, v46, v47
    s_waitcnt lgkmcnt(0)
    v_mfma_f32_32x32x16_bf16 v[32:47], v[80:83], v[8:11], v[112:127]
    ds_read_b128 v[88:91], v3 offset:6144
    ds_read_b128 v[92:95], v3 offset:7168
    v_exp_f32 v48, v48
    v_exp_f32 v49, v49
    v_exp_f32 v50, v50
    v_exp_f32 v51, v51
    v_cvt_pk_bf16_f32 v72, v48, v49
    v_cvt_pk_bf16_f32 v73, v50, v51
    v_mfma_f32_32x32x16_bf16 v[16:31], v[96:99], v[64:67], v[16:31]
    ds_read_b128 v[104:107], v3 offset:18432
    ds_read_b128 v[108:111], v3 offset:19456
    buffer_load_dwordx4 v3, s[48:51], s72 offen offset:2048 lds
    v_exp_f32 v52, v52
    v_exp_f32 v53, v53
    v_exp_f32 v54, v54
    v_exp_f32 v55, v55
    v_cvt_pk_bf16_f32 v74, v52, v53
    v_cvt_pk_bf16_f32 v75, v54, v55
    v_mfma_f32_32x32x16_bf16 v[32:47], v[84:87], v[12:15], v[32:47]
    buffer_load_dwordx4 v3, s[48:51], s72 offen offset:3072 lds
    v_exp_f32 v56, v56
    v_exp_f32 v57, v57
    v_exp_f32 v58, v58
    v_exp_f32 v59, v59
    v_cvt_pk_bf16_f32 v76, v56, v57
    v_cvt_pk_bf16_f32 v77, v58, v59
    v_mfma_f32_32x32x16_bf16 v[16:31], v[100:103], v[68:71], v[16:31]
    v_exp_f32 v60, v60
    v_exp_f32 v61, v61
    v_exp_f32 v62, v62
    v_exp_f32 v63, v63
    v_cvt_pk_bf16_f32 v78, v60, v61
    v_cvt_pk_bf16_f32 v79, v62, v63
    s_waitcnt lgkmcnt(0)
    v_mfma_f32_32x32x16_bf16 v[48:63], v[88:91], v[8:11], v[112:127]
    ds_read_b128 v[80:83], v3 offset:8192
    ds_read_b128 v[84:87], v3 offset:9216
    v_exp_f32 v32, v32
    v_exp_f32 v33, v33
    v_exp_f32 v34, v34
    v_exp_f32 v35, v35
    v_cvt_pk_bf16_f32 v64, v32, v33
    v_cvt_pk_bf16_f32 v65, v34, v35
    v_mfma_f32_32x32x16_bf16 v[16:31], v[104:107], v[72:75], v[16:31]
    ds_read_b128 v[96:99], v3 offset:20480
    ds_read_b128 v[100:103], v3 offset:21504
    s_add_u32 s71, s69, 81920
    s_mov_b32 m0, s71
    s_add_u32 s72, s70, 32768
    buffer_load_dwordx4 v3, s[52:55], s72 offen offset:0 lds
    v_exp_f32 v36, v36
    v_exp_f32 v37, v37
    v_exp_f32 v38, v38
    v_exp_f32 v39, v39
    v_cvt_pk_bf16_f32 v66, v36, v37
    v_cvt_pk_bf16_f32 v67, v38, v39
    v_mfma_f32_32x32x16_bf16 v[48:63], v[92:95], v[12:15], v[48:63]
    buffer_load_dwordx4 v3, s[52:55], s72 offen offset:1024 lds
    v_exp_f32 v40, v40
    v_exp_f32 v41, v41
    v_exp_f32 v42, v42
    v_exp_f32 v43, v43
    v_cvt_pk_bf16_f32 v68, v40, v41
    v_cvt_pk_bf16_f32 v69, v42, v43
    v_mfma_f32_32x32x16_bf16 v[16:31], v[108:111], v[76:79], v[16:31]
    v_exp_f32 v44, v44
    v_exp_f32 v45, v45
    v_exp_f32 v46, v46
    v_exp_f32 v47, v47
    v_cvt_pk_bf16_f32 v70, v44, v45
    v_cvt_pk_bf16_f32 v71, v46, v47
    s_waitcnt lgkmcnt(0)
    v_mfma_f32_32x32x16_bf16 v[32:47], v[80:83], v[8:11], v[112:127]
    ds_read_b128 v[88:91], v3 offset:10240
    ds_read_b128 v[92:95], v3 offset:11264
    v_exp_f32 v48, v48
    v_exp_f32 v49, v49
    v_exp_f32 v50, v50
    v_exp_f32 v51, v51
    v_cvt_pk_bf16_f32 v72, v48, v49
    v_cvt_pk_bf16_f32 v73, v50, v51
    v_mfma_f32_32x32x16_bf16 v[16:31], v[96:99], v[64:67], v[16:31]
    ds_read_b128 v[104:107], v3 offset:22528
    ds_read_b128 v[108:111], v3 offset:23552
    buffer_load_dwordx4 v3, s[52:55], s72 offen offset:2048 lds
    v_exp_f32 v52, v52
    v_exp_f32 v53, v53
    v_exp_f32 v54, v54
    v_exp_f32 v55, v55
    v_cvt_pk_bf16_f32 v74, v52, v53
    v_cvt_pk_bf16_f32 v75, v54, v55
    v_mfma_f32_32x32x16_bf16 v[32:47], v[84:87], v[12:15], v[32:47]
    buffer_load_dwordx4 v3, s[52:55], s72 offen offset:3072 lds
    v_exp_f32 v56, v56
    v_exp_f32 v57, v57
    v_exp_f32 v58, v58
    v_exp_f32 v59, v59
    v_cvt_pk_bf16_f32 v76, v56, v57
    v_cvt_pk_bf16_f32 v77, v58, v59
    v_mfma_f32_32x32x16_bf16 v[16:31], v[100:103], v[68:71], v[16:31]
    v_exp_f32 v60, v60
    v_exp_f32 v61, v61
    v_exp_f32 v62, v62
    v_exp_f32 v63, v63
    v_cvt_pk_bf16_f32 v78, v60, v61
    v_cvt_pk_bf16_f32 v79, v62, v63
    s_waitcnt lgkmcnt(0)
    v_mfma_f32_32x32x16_bf16 v[48:63], v[88:91], v[8:11], v[112:127]
    ds_read_b128 v[80:83], v3 offset:12288
    ds_read_b128 v[84:87], v3 offset:13312
    v_exp_f32 v32, v32
    v_exp_f32 v33, v33
    v_exp_f32 v34, v34
    v_exp_f32 v35, v35
    v_cvt_pk_bf16_f32 v64, v32, v33
    v_cvt_pk_bf16_f32 v65, v34, v35
    v_mfma_f32_32x32x16_bf16 v[16:31], v[104:107], v[72:75], v[16:31]
    ds_read_b128 v[96:99], v3 offset:24576
    ds_read_b128 v[100:103], v3 offset:25600
    v_exp_f32 v36, v36
    v_exp_f32 v37, v37
    v_exp_f32 v38, v38
    v_exp_f32 v39, v39
    v_cvt_pk_bf16_f32 v66, v36, v37
    v_cvt_pk_bf16_f32 v67, v38, v39
    v_mfma_f32_32x32x16_bf16 v[48:63], v[92:95], v[12:15], v[48:63]
    v_exp_f32 v40, v40
    v_exp_f32 v41, v41
    v_exp_f32 v42, v42
    v_exp_f32 v43, v43
    v_cvt_pk_bf16_f32 v68, v40, v41
    v_cvt_pk_bf16_f32 v69, v42, v43
    v_mfma_f32_32x32x16_bf16 v[16:31], v[108:111], v[76:79], v[16:31]
    v_exp_f32 v44, v44
    v_exp_f32 v45, v45
    v_exp_f32 v46, v46
    v_exp_f32 v47, v47
    v_cvt_pk_bf16_f32 v70, v44, v45
    v_cvt_pk_bf16_f32 v71, v46, v47
    s_waitcnt lgkmcnt(0)
    v_mfma_f32_32x32x16_bf16 v[32:47], v[80:83], v[8:11], v[112:127]
    ds_read_b128 v[88:91], v3 offset:14336
    ds_read_b128 v[92:95], v3 offset:15360
    v_exp_f32 v48, v48
    v_exp_f32 v49, v49
    v_exp_f32 v50, v50
    v_exp_f32 v51, v51
    v_cvt_pk_bf16_f32 v72, v48, v49
    v_cvt_pk_bf16_f32 v73, v50, v51
    v_mfma_f32_32x32x16_bf16 v[16:31], v[96:99], v[64:67], v[16:31]
    ds_read_b128 v[104:107], v3 offset:26624
    ds_read_b128 v[108:111], v3 offset:27648
    v_exp_f32 v52, v52
    v_exp_f32 v53, v53
    v_exp_f32 v54, v54
    v_exp_f32 v55, v55
    v_cvt_pk_bf16_f32 v74, v52, v53
    v_cvt_pk_bf16_f32 v75, v54, v55
    v_mfma_f32_32x32x16_bf16 v[32:47], v[84:87], v[12:15], v[32:47]
    v_exp_f32 v56, v56
    v_exp_f32 v57, v57
    v_exp_f32 v58, v58
    v_exp_f32 v59, v59
    v_cvt_pk_bf16_f32 v76, v56, v57
    v_cvt_pk_bf16_f32 v77, v58, v59
    v_mfma_f32_32x32x16_bf16 v[16:31], v[100:103], v[68:71], v[16:31]
    v_exp_f32 v60, v60
    v_exp_f32 v61, v61
    v_exp_f32 v62, v62
    v_exp_f32 v63, v63
    v_cvt_pk_bf16_f32 v78, v60, v61
    v_cvt_pk_bf16_f32 v79, v62, v63
    s_waitcnt vmcnt(8) lgkmcnt(0)
    s_barrier
    v_mfma_f32_32x32x16_bf16 v[48:63], v[88:91], v[8:11], v[112:127]
    ds_read_b128 v[80:83], v3 offset:32768
    ds_read_b128 v[84:87], v3 offset:33792
    v_exp_f32 v32, v32
    v_exp_f32 v33, v33
    v_exp_f32 v34, v34
    v_exp_f32 v35, v35
    v_cvt_pk_bf16_f32 v64, v32, v33
    v_cvt_pk_bf16_f32 v65, v34, v35
    v_mfma_f32_32x32x16_bf16 v[16:31], v[104:107], v[72:75], v[16:31]
    ds_read_b128 v[96:99], v3 offset:28672
    ds_read_b128 v[100:103], v3 offset:29696
    s_add_u32 s71, s69, 98304
    s_mov_b32 m0, s71
    s_add_u32 s72, s70, 49152
    buffer_load_dwordx4 v3, s[48:51], s72 offen offset:0 lds
    v_exp_f32 v36, v36
    v_exp_f32 v37, v37
    v_exp_f32 v38, v38
    v_exp_f32 v39, v39
    v_cvt_pk_bf16_f32 v66, v36, v37
    v_cvt_pk_bf16_f32 v67, v38, v39
    v_mfma_f32_32x32x16_bf16 v[48:63], v[92:95], v[12:15], v[48:63]
    buffer_load_dwordx4 v3, s[48:51], s72 offen offset:1024 lds
    v_exp_f32 v40, v40
    v_exp_f32 v41, v41
    v_exp_f32 v42, v42
    v_exp_f32 v43, v43
    v_cvt_pk_bf16_f32 v68, v40, v41
    v_cvt_pk_bf16_f32 v69, v42, v43
    v_mfma_f32_32x32x16_bf16 v[16:31], v[108:111], v[76:79], v[16:31]
    v_exp_f32 v44, v44
    v_exp_f32 v45, v45
    v_exp_f32 v46, v46
    v_exp_f32 v47, v47
    v_cvt_pk_bf16_f32 v70, v44, v45
    v_cvt_pk_bf16_f32 v71, v46, v47
    s_waitcnt lgkmcnt(0)
    v_mfma_f32_32x32x16_bf16 v[32:47], v[80:83], v[8:11], v[112:127]
    ds_read_b128 v[88:91], v3 offset:34816
    ds_read_b128 v[92:95], v3 offset:35840
    v_exp_f32 v48, v48
    v_exp_f32 v49, v49
    v_exp_f32 v50, v50
    v_exp_f32 v51, v51
    v_cvt_pk_bf16_f32 v72, v48, v49
    v_cvt_pk_bf16_f32 v73, v50, v51
    v_mfma_f32_32x32x16_bf16 v[16:31], v[96:99], v[64:67], v[16:31]
    ds_read_b128 v[104:107], v3 offset:30720
    ds_read_b128 v[108:111], v3 offset:31744
    buffer_load_dwordx4 v3, s[48:51], s72 offen offset:2048 lds
    v_exp_f32 v52, v52
    v_exp_f32 v53, v53
    v_exp_f32 v54, v54
    v_exp_f32 v55, v55
    v_cvt_pk_bf16_f32 v74, v52, v53
    v_cvt_pk_bf16_f32 v75, v54, v55
    v_mfma_f32_32x32x16_bf16 v[32:47], v[84:87], v[12:15], v[32:47]
    buffer_load_dwordx4 v3, s[48:51], s72 offen offset:3072 lds
    v_exp_f32 v56, v56
    v_exp_f32 v57, v57
    v_exp_f32 v58, v58
    v_exp_f32 v59, v59
    v_cvt_pk_bf16_f32 v76, v56, v57
    v_cvt_pk_bf16_f32 v77, v58, v59
    v_mfma_f32_32x32x16_bf16 v[16:31], v[100:103], v[68:71], v[16:31]
    v_exp_f32 v60, v60
    v_exp_f32 v61, v61
    v_exp_f32 v62, v62
    v_exp_f32 v63, v63
    v_cvt_pk_bf16_f32 v78, v60, v61
    v_cvt_pk_bf16_f32 v79, v62, v63
    s_waitcnt lgkmcnt(0)
    v_mfma_f32_32x32x16_bf16 v[48:63], v[88:91], v[8:11], v[112:127]
    ds_read_b128 v[80:83], v3 offset:36864
    ds_read_b128 v[84:87], v3 offset:37888
    v_exp_f32 v32, v32
    v_exp_f32 v33, v33
    v_exp_f32 v34, v34
    v_exp_f32 v35, v35
    v_cvt_pk_bf16_f32 v64, v32, v33
    v_cvt_pk_bf16_f32 v65, v34, v35
    v_mfma_f32_32x32x16_bf16 v[16:31], v[104:107], v[72:75], v[16:31]
    ds_read_b128 v[96:99], v3 offset:49152
    ds_read_b128 v[100:103], v3 offset:50176
    s_add_u32 s71, s69, 114688
    s_mov_b32 m0, s71
    s_add_u32 s72, s70, 49152
    buffer_load_dwordx4 v3, s[52:55], s72 offen offset:0 lds
    v_exp_f32 v36, v36
    v_exp_f32 v37, v37
    v_exp_f32 v38, v38
    v_exp_f32 v39, v39
    v_cvt_pk_bf16_f32 v66, v36, v37
    v_cvt_pk_bf16_f32 v67, v38, v39
    v_mfma_f32_32x32x16_bf16 v[48:63], v[92:95], v[12:15], v[48:63]
    buffer_load_dwordx4 v3, s[52:55], s72 offen offset:1024 lds
    v_exp_f32 v40, v40
    v_exp_f32 v41, v41
    v_exp_f32 v42, v42
    v_exp_f32 v43, v43
    v_cvt_pk_bf16_f32 v68, v40, v41
    v_cvt_pk_bf16_f32 v69, v42, v43
    v_mfma_f32_32x32x16_bf16 v[16:31], v[108:111], v[76:79], v[16:31]
    v_exp_f32 v44, v44
    v_exp_f32 v45, v45
    v_exp_f32 v46, v46
    v_exp_f32 v47, v47
    v_cvt_pk_bf16_f32 v70, v44, v45
    v_cvt_pk_bf16_f32 v71, v46, v47
    s_waitcnt lgkmcnt(0)
    v_mfma_f32_32x32x16_bf16 v[32:47], v[80:83], v[8:11], v[112:127]
    ds_read_b128 v[88:91], v3 offset:38912
    ds_read_b128 v[92:95], v3 offset:39936
    v_exp_f32 v48, v48
    v_exp_f32 v49, v49
    v_exp_f32 v50, v50
    v_exp_f32 v51, v51
    v_cvt_pk_bf16_f32 v72, v48, v49
    v_cvt_pk_bf16_f32 v73, v50, v51
    v_mfma_f32_32x32x16_bf16 v[16:31], v[96:99], v[64:67], v[16:31]
    ds_read_b128 v[104:107], v3 offset:51200
    ds_read_b128 v[108:111], v3 offset:52224
    buffer_load_dwordx4 v3, s[52:55], s72 offen offset:2048 lds
    v_exp_f32 v52, v52
    v_exp_f32 v53, v53
    v_exp_f32 v54, v54
    v_exp_f32 v55, v55
    v_cvt_pk_bf16_f32 v74, v52, v53
    v_cvt_pk_bf16_f32 v75, v54, v55
    v_mfma_f32_32x32x16_bf16 v[32:47], v[84:87], v[12:15], v[32:47]
    buffer_load_dwordx4 v3, s[52:55], s72 offen offset:3072 lds
    v_exp_f32 v56, v56
    v_exp_f32 v57, v57
    v_exp_f32 v58, v58
    v_exp_f32 v59, v59
    v_cvt_pk_bf16_f32 v76, v56, v57
    v_cvt_pk_bf16_f32 v77, v58, v59
    v_mfma_f32_32x32x16_bf16 v[16:31], v[100:103], v[68:71], v[16:31]
    v_exp_f32 v60, v60
    v_exp_f32 v61, v61
    v_exp_f32 v62, v62
    v_exp_f32 v63, v63
    v_cvt_pk_bf16_f32 v78, v60, v61
    v_cvt_pk_bf16_f32 v79, v62, v63
    s_waitcnt lgkmcnt(0)
    v_mfma_f32_32x32x16_bf16 v[48:63], v[88:91], v[8:11], v[112:127]
    ds_read_b128 v[80:83], v3 offset:40960
    ds_read_b128 v[84:87], v3 offset:41984
    v_exp_f32 v32, v32
    v_exp_f32 v33, v33
    v_exp_f32 v34, v34
    v_exp_f32 v35, v35
    v_cvt_pk_bf16_f32 v64, v32, v33
    v_cvt_pk_bf16_f32 v65, v34, v35
    v_mfma_f32_32x32x16_bf16 v[16:31], v[104:107], v[72:75], v[16:31]
    ds_read_b128 v[96:99], v3 offset:53248
    ds_read_b128 v[100:103], v3 offset:54272
    v_exp_f32 v36, v36
    v_exp_f32 v37, v37
    v_exp_f32 v38, v38
    v_exp_f32 v39, v39
    v_cvt_pk_bf16_f32 v66, v36, v37
    v_cvt_pk_bf16_f32 v67, v38, v39
    v_mfma_f32_32x32x16_bf16 v[48:63], v[92:95], v[12:15], v[48:63]
    v_exp_f32 v40, v40
    v_exp_f32 v41, v41
    v_exp_f32 v42, v42
    v_exp_f32 v43, v43
    v_cvt_pk_bf16_f32 v68, v40, v41
    v_cvt_pk_bf16_f32 v69, v42, v43
    v_mfma_f32_32x32x16_bf16 v[16:31], v[108:111], v[76:79], v[16:31]
    v_exp_f32 v44, v44
    v_exp_f32 v45, v45
    v_exp_f32 v46, v46
    v_exp_f32 v47, v47
    v_cvt_pk_bf16_f32 v70, v44, v45
    v_cvt_pk_bf16_f32 v71, v46, v47
    s_waitcnt lgkmcnt(0)
    v_mfma_f32_32x32x16_bf16 v[32:47], v[80:83], v[8:11], v[112:127]
    ds_read_b128 v[88:91], v3 offset:43008
    ds_read_b128 v[92:95], v3 offset:44032
    v_exp_f32 v48, v48
    v_exp_f32 v49, v49
    v_exp_f32 v50, v50
    v_exp_f32 v51, v51
    v_cvt_pk_bf16_f32 v72, v48, v49
    v_cvt_pk_bf16_f32 v73, v50, v51
    v_mfma_f32_32x32x16_bf16 v[16:31], v[96:99], v[64:67], v[16:31]
    ds_read_b128 v[104:107], v3 offset:55296
    ds_read_b128 v[108:111], v3 offset:56320
    v_exp_f32 v52, v52
    v_exp_f32 v53, v53
    v_exp_f32 v54, v54
    v_exp_f32 v55, v55
    v_cvt_pk_bf16_f32 v74, v52, v53
    v_cvt_pk_bf16_f32 v75, v54, v55
    v_mfma_f32_32x32x16_bf16 v[32:47], v[84:87], v[12:15], v[32:47]
    v_exp_f32 v56, v56
    v_exp_f32 v57, v57
    v_exp_f32 v58, v58
    v_exp_f32 v59, v59
    v_cvt_pk_bf16_f32 v76, v56, v57
    v_cvt_pk_bf16_f32 v77, v58, v59
    v_mfma_f32_32x32x16_bf16 v[16:31], v[100:103], v[68:71], v[16:31]
    v_exp_f32 v60, v60
    v_exp_f32 v61, v61
    v_exp_f32 v62, v62
    v_exp_f32 v63, v63
    v_cvt_pk_bf16_f32 v78, v60, v61
    v_cvt_pk_bf16_f32 v79, v62, v63
    s_waitcnt lgkmcnt(0)
    v_mfma_f32_32x32x16_bf16 v[48:63], v[88:91], v[8:11], v[112:127]
    ds_read_b128 v[80:83], v3 offset:45056
    ds_read_b128 v[84:87], v3 offset:46080
    v_exp_f32 v32, v32
    v_exp_f32 v33, v33
    v_exp_f32 v34, v34
    v_exp_f32 v35, v35
    v_cvt_pk_bf16_f32 v64, v32, v33
    v_cvt_pk_bf16_f32 v65, v34, v35
    v_mfma_f32_32x32x16_bf16 v[16:31], v[104:107], v[72:75], v[16:31]
    ds_read_b128 v[96:99], v3 offset:57344
    ds_read_b128 v[100:103], v3 offset:58368
    v_exp_f32 v36, v36
    v_exp_f32 v37, v37
    v_exp_f32 v38, v38
    v_exp_f32 v39, v39
    v_cvt_pk_bf16_f32 v66, v36, v37
    v_cvt_pk_bf16_f32 v67, v38, v39
    v_mfma_f32_32x32x16_bf16 v[48:63], v[92:95], v[12:15], v[48:63]
    v_exp_f32 v40, v40
    v_exp_f32 v41, v41
    v_exp_f32 v42, v42
    v_exp_f32 v43, v43
    v_cvt_pk_bf16_f32 v68, v40, v41
    v_cvt_pk_bf16_f32 v69, v42, v43
    v_mfma_f32_32x32x16_bf16 v[16:31], v[108:111], v[76:79], v[16:31]
    v_exp_f32 v44, v44
    v_exp_f32 v45, v45
    v_exp_f32 v46, v46
    v_exp_f32 v47, v47
    v_cvt_pk_bf16_f32 v70, v44, v45
    v_cvt_pk_bf16_f32 v71, v46, v47
    s_waitcnt lgkmcnt(0)
    v_mfma_f32_32x32x16_bf16 v[32:47], v[80:83], v[8:11], v[112:127]
    ds_read_b128 v[88:91], v3 offset:47104
    ds_read_b128 v[92:95], v3 offset:48128
    v_exp_f32 v48, v48
    v_exp_f32 v49, v49
    v_exp_f32 v50, v50
    v_exp_f32 v51, v51
    v_cvt_pk_bf16_f32 v72, v48, v49
    v_cvt_pk_bf16_f32 v73, v50, v51
    v_mfma_f32_32x32x16_bf16 v[16:31], v[96:99], v[64:67], v[16:31]
    ds_read_b128 v[104:107], v3 offset:59392
    ds_read_b128 v[108:111], v3 offset:60416
    v_exp_f32 v52, v52
    v_exp_f32 v53, v53
    v_exp_f32 v54, v54
    v_exp_f32 v55, v55
    v_cvt_pk_bf16_f32 v74, v52, v53
    v_cvt_pk_bf16_f32 v75, v54, v55
    v_mfma_f32_32x32x16_bf16 v[32:47], v[84:87], v[12:15], v[32:47]
    v_exp_f32 v56, v56
    v_exp_f32 v57, v57
    v_exp_f32 v58, v58
    v_exp_f32 v59, v59
    v_cvt_pk_bf16_f32 v76, v56, v57
    v_cvt_pk_bf16_f32 v77, v58, v59
    v_mfma_f32_32x32x16_bf16 v[16:31], v[100:103], v[68:71], v[16:31]
    v_exp_f32 v60, v60
    v_exp_f32 v61, v61
    v_exp_f32 v62, v62
    v_exp_f32 v63, v63
    v_cvt_pk_bf16_f32 v78, v60, v61
    v_cvt_pk_bf16_f32 v79, v62, v63
    s_waitcnt vmcnt(8) lgkmcnt(0)
    s_barrier
    v_mfma_f32_32x32x16_bf16 v[48:63], v[88:91], v[8:11], v[112:127]
    ds_read_b128 v[80:83], v4 offset:0
    ds_read_b128 v[84:87], v4 offset:1024
    v_exp_f32 v32, v32
    v_exp_f32 v33, v33
    v_exp_f32 v34, v34
    v_exp_f32 v35, v35
    v_cvt_pk_bf16_f32 v64, v32, v33
    v_cvt_pk_bf16_f32 v65, v34, v35
    v_mfma_f32_32x32x16_bf16 v[16:31], v[104:107], v[72:75], v[16:31]
    ds_read_b128 v[96:99], v3 offset:61440
    ds_read_b128 v[100:103], v3 offset:62464
    s_add_u32 s71, s69, 0
    s_mov_b32 m0, s71
    s_add_u32 s72, s70, 65536
    buffer_load_dwordx4 v3, s[48:51], s72 offen offset:0 lds
    v_exp_f32 v36, v36
    v_exp_f32 v37, v37
    v_exp_f32 v38, v38
    v_exp_f32 v39, v39
    v_cvt_pk_bf16_f32 v66, v36, v37
    v_cvt_pk_bf16_f32 v67, v38, v39
    v_mfma_f32_32x32x16_bf16 v[48:63], v[92:95], v[12:15], v[48:63]
    buffer_load_dwordx4 v3, s[48:51], s72 offen offset:1024 lds
    v_exp_f32 v40, v40
    v_exp_f32 v41, v41
    v_exp_f32 v42, v42
    v_exp_f32 v43, v43
    v_cvt_pk_bf16_f32 v68, v40, v41
    v_cvt_pk_bf16_f32 v69, v42, v43
    v_mfma_f32_32x32x16_bf16 v[16:31], v[108:111], v[76:79], v[16:31]
    v_exp_f32 v44, v44
    v_exp_f32 v45, v45
    v_exp_f32 v46, v46
    v_exp_f32 v47, v47
    v_cvt_pk_bf16_f32 v70, v44, v45
    v_cvt_pk_bf16_f32 v71, v46, v47
    s_waitcnt lgkmcnt(0)
    v_mfma_f32_32x32x16_bf16 v[32:47], v[80:83], v[8:11], v[112:127]
    ds_read_b128 v[88:91], v4 offset:2048
    ds_read_b128 v[92:95], v4 offset:3072
    v_exp_f32 v48, v48
    v_exp_f32 v49, v49
    v_exp_f32 v50, v50
    v_exp_f32 v51, v51
    v_cvt_pk_bf16_f32 v72, v48, v49
    v_cvt_pk_bf16_f32 v73, v50, v51
    v_mfma_f32_32x32x16_bf16 v[16:31], v[96:99], v[64:67], v[16:31]
    ds_read_b128 v[104:107], v3 offset:63488
    ds_read_b128 v[108:111], v3 offset:64512
    buffer_load_dwordx4 v3, s[48:51], s72 offen offset:2048 lds
    v_exp_f32 v52, v52
    v_exp_f32 v53, v53
    v_exp_f32 v54, v54
    v_exp_f32 v55, v55
    v_cvt_pk_bf16_f32 v74, v52, v53
    v_cvt_pk_bf16_f32 v75, v54, v55
    v_mfma_f32_32x32x16_bf16 v[32:47], v[84:87], v[12:15], v[32:47]
    buffer_load_dwordx4 v3, s[48:51], s72 offen offset:3072 lds
    v_exp_f32 v56, v56
    v_exp_f32 v57, v57
    v_exp_f32 v58, v58
    v_exp_f32 v59, v59
    v_cvt_pk_bf16_f32 v76, v56, v57
    v_cvt_pk_bf16_f32 v77, v58, v59
    v_mfma_f32_32x32x16_bf16 v[16:31], v[100:103], v[68:71], v[16:31]
    v_exp_f32 v60, v60
    v_exp_f32 v61, v61
    v_exp_f32 v62, v62
    v_exp_f32 v63, v63
    v_cvt_pk_bf16_f32 v78, v60, v61
    v_cvt_pk_bf16_f32 v79, v62, v63
    s_waitcnt lgkmcnt(0)
    v_mfma_f32_32x32x16_bf16 v[48:63], v[88:91], v[8:11], v[112:127]
    ds_read_b128 v[80:83], v4 offset:4096
    ds_read_b128 v[84:87], v4 offset:5120
    v_exp_f32 v32, v32
    v_exp_f32 v33, v33
    v_exp_f32 v34, v34
    v_exp_f32 v35, v35
    v_cvt_pk_bf16_f32 v64, v32, v33
    v_cvt_pk_bf16_f32 v65, v34, v35
    v_mfma_f32_32x32x16_bf16 v[16:31], v[104:107], v[72:75], v[16:31]
    ds_read_b128 v[96:99], v4 offset:16384
    ds_read_b128 v[100:103], v4 offset:17408
    s_add_u32 s71, s69, 16384
    s_mov_b32 m0, s71
    s_add_u32 s72, s70, 65536
    buffer_load_dwordx4 v3, s[52:55], s72 offen offset:0 lds
    v_exp_f32 v36, v36
    v_exp_f32 v37, v37
    v_exp_f32 v38, v38
    v_exp_f32 v39, v39
    v_cvt_pk_bf16_f32 v66, v36, v37
    v_cvt_pk_bf16_f32 v67, v38, v39
    v_mfma_f32_32x32x16_bf16 v[48:63], v[92:95], v[12:15], v[48:63]
    buffer_load_dwordx4 v3, s[52:55], s72 offen offset:1024 lds
    v_exp_f32 v40, v40
    v_exp_f32 v41, v41
    v_exp_f32 v42, v42
    v_exp_f32 v43, v43
    v_cvt_pk_bf16_f32 v68, v40, v41
    v_cvt_pk_bf16_f32 v69, v42, v43
    v_mfma_f32_32x32x16_bf16 v[16:31], v[108:111], v[76:79], v[16:31]
    v_exp_f32 v44, v44
    v_exp_f32 v45, v45
    v_exp_f32 v46, v46
    v_exp_f32 v47, v47
    v_cvt_pk_bf16_f32 v70, v44, v45
    v_cvt_pk_bf16_f32 v71, v46, v47
    s_waitcnt lgkmcnt(0)
    v_mfma_f32_32x32x16_bf16 v[32:47], v[80:83], v[8:11], v[112:127]
    ds_read_b128 v[88:91], v4 offset:6144
    ds_read_b128 v[92:95], v4 offset:7168
    v_exp_f32 v48, v48
    v_exp_f32 v49, v49
    v_exp_f32 v50, v50
    v_exp_f32 v51, v51
    v_cvt_pk_bf16_f32 v72, v48, v49
    v_cvt_pk_bf16_f32 v73, v50, v51
    v_mfma_f32_32x32x16_bf16 v[16:31], v[96:99], v[64:67], v[16:31]
    ds_read_b128 v[104:107], v4 offset:18432
    ds_read_b128 v[108:111], v4 offset:19456
    buffer_load_dwordx4 v3, s[52:55], s72 offen offset:2048 lds
    v_exp_f32 v52, v52
    v_exp_f32 v53, v53
    v_exp_f32 v54, v54
    v_exp_f32 v55, v55
    v_cvt_pk_bf16_f32 v74, v52, v53
    v_cvt_pk_bf16_f32 v75, v54, v55
    v_mfma_f32_32x32x16_bf16 v[32:47], v[84:87], v[12:15], v[32:47]
    buffer_load_dwordx4 v3, s[52:55], s72 offen offset:3072 lds
    v_exp_f32 v56, v56
    v_exp_f32 v57, v57
    v_exp_f32 v58, v58
    v_exp_f32 v59, v59
    v_cvt_pk_bf16_f32 v76, v56, v57
    v_cvt_pk_bf16_f32 v77, v58, v59
    v_mfma_f32_32x32x16_bf16 v[16:31], v[100:103], v[68:71], v[16:31]
    v_exp_f32 v60, v60
    v_exp_f32 v61, v61
    v_exp_f32 v62, v62
    v_exp_f32 v63, v63
    v_cvt_pk_bf16_f32 v78, v60, v61
    v_cvt_pk_bf16_f32 v79, v62, v63
    s_waitcnt lgkmcnt(0)
    v_mfma_f32_32x32x16_bf16 v[48:63], v[88:91], v[8:11], v[112:127]
    ds_read_b128 v[80:83], v4 offset:8192
    ds_read_b128 v[84:87], v4 offset:9216
    v_exp_f32 v32, v32
    v_exp_f32 v33, v33
    v_exp_f32 v34, v34
    v_exp_f32 v35, v35
    v_cvt_pk_bf16_f32 v64, v32, v33
    v_cvt_pk_bf16_f32 v65, v34, v35
    v_mfma_f32_32x32x16_bf16 v[16:31], v[104:107], v[72:75], v[16:31]
    ds_read_b128 v[96:99], v4 offset:20480
    ds_read_b128 v[100:103], v4 offset:21504
    v_exp_f32 v36, v36
    v_exp_f32 v37, v37
    v_exp_f32 v38, v38
    v_exp_f32 v39, v39
    v_cvt_pk_bf16_f32 v66, v36, v37
    v_cvt_pk_bf16_f32 v67, v38, v39
    v_mfma_f32_32x32x16_bf16 v[48:63], v[92:95], v[12:15], v[48:63]
    v_exp_f32 v40, v40
    v_exp_f32 v41, v41
    v_exp_f32 v42, v42
    v_exp_f32 v43, v43
    v_cvt_pk_bf16_f32 v68, v40, v41
    v_cvt_pk_bf16_f32 v69, v42, v43
    v_mfma_f32_32x32x16_bf16 v[16:31], v[108:111], v[76:79], v[16:31]
    v_exp_f32 v44, v44
    v_exp_f32 v45, v45
    v_exp_f32 v46, v46
    v_exp_f32 v47, v47
    v_cvt_pk_bf16_f32 v70, v44, v45
    v_cvt_pk_bf16_f32 v71, v46, v47
    s_waitcnt lgkmcnt(0)
    v_mfma_f32_32x32x16_bf16 v[32:47], v[80:83], v[8:11], v[112:127]
    ds_read_b128 v[88:91], v4 offset:10240
    ds_read_b128 v[92:95], v4 offset:11264
    v_exp_f32 v48, v48
    v_exp_f32 v49, v49
    v_exp_f32 v50, v50
    v_exp_f32 v51, v51
    v_cvt_pk_bf16_f32 v72, v48, v49
    v_cvt_pk_bf16_f32 v73, v50, v51
    v_mfma_f32_32x32x16_bf16 v[16:31], v[96:99], v[64:67], v[16:31]
    ds_read_b128 v[104:107], v4 offset:22528
    ds_read_b128 v[108:111], v4 offset:23552
    v_exp_f32 v52, v52
    v_exp_f32 v53, v53
    v_exp_f32 v54, v54
    v_exp_f32 v55, v55
    v_cvt_pk_bf16_f32 v74, v52, v53
    v_cvt_pk_bf16_f32 v75, v54, v55
    v_mfma_f32_32x32x16_bf16 v[32:47], v[84:87], v[12:15], v[32:47]
    v_exp_f32 v56, v56
    v_exp_f32 v57, v57
    v_exp_f32 v58, v58
    v_exp_f32 v59, v59
    v_cvt_pk_bf16_f32 v76, v56, v57
    v_cvt_pk_bf16_f32 v77, v58, v59
    v_mfma_f32_32x32x16_bf16 v[16:31], v[100:103], v[68:71], v[16:31]
    v_exp_f32 v60, v60
    v_exp_f32 v61, v61
    v_exp_f32 v62, v62
    v_exp_f32 v63, v63
    v_cvt_pk_bf16_f32 v78, v60, v61
    v_cvt_pk_bf16_f32 v79, v62, v63
    s_waitcnt lgkmcnt(0)
    v_mfma_f32_32x32x16_bf16 v[48:63], v[88:91], v[8:11], v[112:127]
    ds_read_b128 v[80:83], v4 offset:12288
    ds_read_b128 v[84:87], v4 offset:13312
    v_exp_f32 v32, v32
    v_exp_f32 v33, v33
    v_exp_f32 v34, v34
    v_exp_f32 v35, v35
    v_cvt_pk_bf16_f32 v64, v32, v33
    v_cvt_pk_bf16_f32 v65, v34, v35
    v_mfma_f32_32x32x16_bf16 v[16:31], v[104:107], v[72:75], v[16:31]
    ds_read_b128 v[96:99], v4 offset:24576
    ds_read_b128 v[100:103], v4 offset:25600
    v_exp_f32 v36, v36
    v_exp_f32 v37, v37
    v_exp_f32 v38, v38
    v_exp_f32 v39, v39
    v_cvt_pk_bf16_f32 v66, v36, v37
    v_cvt_pk_bf16_f32 v67, v38, v39
    v_mfma_f32_32x32x16_bf16 v[48:63], v[92:95], v[12:15], v[48:63]
    v_exp_f32 v40, v40
    v_exp_f32 v41, v41
    v_exp_f32 v42, v42
    v_exp_f32 v43, v43
    v_cvt_pk_bf16_f32 v68, v40, v41
    v_cvt_pk_bf16_f32 v69, v42, v43
    v_mfma_f32_32x32x16_bf16 v[16:31], v[108:111], v[76:79], v[16:31]
    v_exp_f32 v44, v44
    v_exp_f32 v45, v45
    v_exp_f32 v46, v46
    v_exp_f32 v47, v47
    v_cvt_pk_bf16_f32 v70, v44, v45
    v_cvt_pk_bf16_f32 v71, v46, v47
    s_waitcnt lgkmcnt(0)
    v_mfma_f32_32x32x16_bf16 v[32:47], v[80:83], v[8:11], v[112:127]
    ds_read_b128 v[88:91], v4 offset:14336
    ds_read_b128 v[92:95], v4 offset:15360
    v_exp_f32 v48, v48
    v_exp_f32 v49, v49
    v_exp_f32 v50, v50
    v_exp_f32 v51, v51
    v_cvt_pk_bf16_f32 v72, v48, v49
    v_cvt_pk_bf16_f32 v73, v50, v51
    v_mfma_f32_32x32x16_bf16 v[16:31], v[96:99], v[64:67], v[16:31]
    ds_read_b128 v[104:107], v4 offset:26624
    ds_read_b128 v[108:111], v4 offset:27648
    v_exp_f32 v52, v52
    v_exp_f32 v53, v53
    v_exp_f32 v54, v54
    v_exp_f32 v55, v55
    v_cvt_pk_bf16_f32 v74, v52, v53
    v_cvt_pk_bf16_f32 v75, v54, v55
    v_mfma_f32_32x32x16_bf16 v[32:47], v[84:87], v[12:15], v[32:47]
    v_exp_f32 v56, v56
    v_exp_f32 v57, v57
    v_exp_f32 v58, v58
    v_exp_f32 v59, v59
    v_cvt_pk_bf16_f32 v76, v56, v57
    v_cvt_pk_bf16_f32 v77, v58, v59
    v_mfma_f32_32x32x16_bf16 v[16:31], v[100:103], v[68:71], v[16:31]
    v_exp_f32 v60, v60
    v_exp_f32 v61, v61
    v_exp_f32 v62, v62
    v_exp_f32 v63, v63
    v_cvt_pk_bf16_f32 v78, v60, v61
    v_cvt_pk_bf16_f32 v79, v62, v63
    s_waitcnt vmcnt(8) lgkmcnt(0)
    s_barrier
    v_mfma_f32_32x32x16_bf16 v[48:63], v[88:91], v[8:11], v[112:127]
    ds_read_b128 v[80:83], v4 offset:32768
    ds_read_b128 v[84:87], v4 offset:33792
    v_exp_f32 v32, v32
    v_exp_f32 v33, v33
    v_exp_f32 v34, v34
    v_exp_f32 v35, v35
    v_cvt_pk_bf16_f32 v64, v32, v33
    v_cvt_pk_bf16_f32 v65, v34, v35
    v_mfma_f32_32x32x16_bf16 v[16:31], v[104:107], v[72:75], v[16:31]
    ds_read_b128 v[96:99], v4 offset:28672
    ds_read_b128 v[100:103], v4 offset:29696
    s_add_u32 s71, s69, 32768
    s_mov_b32 m0, s71
    s_add_u32 s72, s70, 81920
    buffer_load_dwordx4 v3, s[48:51], s72 offen offset:0 lds
    v_exp_f32 v36, v36
    v_exp_f32 v37, v37
    v_exp_f32 v38, v38
    v_exp_f32 v39, v39
    v_cvt_pk_bf16_f32 v66, v36, v37
    v_cvt_pk_bf16_f32 v67, v38, v39
    v_mfma_f32_32x32x16_bf16 v[48:63], v[92:95], v[12:15], v[48:63]
    buffer_load_dwordx4 v3, s[48:51], s72 offen offset:1024 lds
    v_exp_f32 v40, v40
    v_exp_f32 v41, v41
    v_exp_f32 v42, v42
    v_exp_f32 v43, v43
    v_cvt_pk_bf16_f32 v68, v40, v41
    v_cvt_pk_bf16_f32 v69, v42, v43
    v_mfma_f32_32x32x16_bf16 v[16:31], v[108:111], v[76:79], v[16:31]
    v_exp_f32 v44, v44
    v_exp_f32 v45, v45
    v_exp_f32 v46, v46
    v_exp_f32 v47, v47
    v_cvt_pk_bf16_f32 v70, v44, v45
    v_cvt_pk_bf16_f32 v71, v46, v47
    s_waitcnt lgkmcnt(0)
    v_mfma_f32_32x32x16_bf16 v[32:47], v[80:83], v[8:11], v[112:127]
    ds_read_b128 v[88:91], v4 offset:34816
    ds_read_b128 v[92:95], v4 offset:35840
    v_exp_f32 v48, v48
    v_exp_f32 v49, v49
    v_exp_f32 v50, v50
    v_exp_f32 v51, v51
    v_cvt_pk_bf16_f32 v72, v48, v49
    v_cvt_pk_bf16_f32 v73, v50, v51
    v_mfma_f32_32x32x16_bf16 v[16:31], v[96:99], v[64:67], v[16:31]
    ds_read_b128 v[104:107], v4 offset:30720
    ds_read_b128 v[108:111], v4 offset:31744
    buffer_load_dwordx4 v3, s[48:51], s72 offen offset:2048 lds
    v_exp_f32 v52, v52
    v_exp_f32 v53, v53
    v_exp_f32 v54, v54
    v_exp_f32 v55, v55
    v_cvt_pk_bf16_f32 v74, v52, v53
    v_cvt_pk_bf16_f32 v75, v54, v55
    v_mfma_f32_32x32x16_bf16 v[32:47], v[84:87], v[12:15], v[32:47]
    buffer_load_dwordx4 v3, s[48:51], s72 offen offset:3072 lds
    v_exp_f32 v56, v56
    v_exp_f32 v57, v57
    v_exp_f32 v58, v58
    v_exp_f32 v59, v59
    v_cvt_pk_bf16_f32 v76, v56, v57
    v_cvt_pk_bf16_f32 v77, v58, v59
    v_mfma_f32_32x32x16_bf16 v[16:31], v[100:103], v[68:71], v[16:31]
    v_exp_f32 v60, v60
    v_exp_f32 v61, v61
    v_exp_f32 v62, v62
    v_exp_f32 v63, v63
    v_cvt_pk_bf16_f32 v78, v60, v61
    v_cvt_pk_bf16_f32 v79, v62, v63
    s_waitcnt lgkmcnt(0)
    v_mfma_f32_32x32x16_bf16 v[48:63], v[88:91], v[8:11], v[112:127]
    ds_read_b128 v[80:83], v4 offset:36864
    ds_read_b128 v[84:87], v4 offset:37888
    v_exp_f32 v32, v32
    v_exp_f32 v33, v33
    v_exp_f32 v34, v34
    v_exp_f32 v35, v35
    v_cvt_pk_bf16_f32 v64, v32, v33
    v_cvt_pk_bf16_f32 v65, v34, v35
    v_mfma_f32_32x32x16_bf16 v[16:31], v[104:107], v[72:75], v[16:31]
    ds_read_b128 v[96:99], v4 offset:49152
    ds_read_b128 v[100:103], v4 offset:50176
    s_add_u32 s71, s69, 49152
    s_mov_b32 m0, s71
    s_add_u32 s72, s70, 81920
    buffer_load_dwordx4 v3, s[52:55], s72 offen offset:0 lds
    v_exp_f32 v36, v36
    v_exp_f32 v37, v37
    v_exp_f32 v38, v38
    v_exp_f32 v39, v39
    v_cvt_pk_bf16_f32 v66, v36, v37
    v_cvt_pk_bf16_f32 v67, v38, v39
    v_mfma_f32_32x32x16_bf16 v[48:63], v[92:95], v[12:15], v[48:63]
    buffer_load_dwordx4 v3, s[52:55], s72 offen offset:1024 lds
    v_exp_f32 v40, v40
    v_exp_f32 v41, v41
    v_exp_f32 v42, v42
    v_exp_f32 v43, v43
    v_cvt_pk_bf16_f32 v68, v40, v41
    v_cvt_pk_bf16_f32 v69, v42, v43
    v_mfma_f32_32x32x16_bf16 v[16:31], v[108:111], v[76:79], v[16:31]
    v_exp_f32 v44, v44
    v_exp_f32 v45, v45
    v_exp_f32 v46, v46
    v_exp_f32 v47, v47
    v_cvt_pk_bf16_f32 v70, v44, v45
    v_cvt_pk_bf16_f32 v71, v46, v47
    s_waitcnt lgkmcnt(0)
    v_mfma_f32_32x32x16_bf16 v[32:47], v[80:83], v[8:11], v[112:127]
    ds_read_b128 v[88:91], v4 offset:38912
    ds_read_b128 v[92:95], v4 offset:39936
    v_exp_f32 v48, v48
    v_exp_f32 v49, v49
    v_exp_f32 v50, v50
    v_exp_f32 v51, v51
    v_cvt_pk_bf16_f32 v72, v48, v49
    v_cvt_pk_bf16_f32 v73, v50, v51
    v_mfma_f32_32x32x16_bf16 v[16:31], v[96:99], v[64:67], v[16:31]
    ds_read_b128 v[104:107], v4 offset:51200
    ds_read_b128 v[108:111], v4 offset:52224
    buffer_load_dwordx4 v3, s[52:55], s72 offen offset:2048 lds
    v_exp_f32 v52, v52
    v_exp_f32 v53, v53
    v_exp_f32 v54, v54
    v_exp_f32 v55, v55
    v_cvt_pk_bf16_f32 v74, v52, v53
    v_cvt_pk_bf16_f32 v75, v54, v55
    v_mfma_f32_32x32x16_bf16 v[32:47], v[84:87], v[12:15], v[32:47]
    buffer_load_dwordx4 v3, s[52:55], s72 offen offset:3072 lds
    v_exp_f32 v56, v56
    v_exp_f32 v57, v57
    v_exp_f32 v58, v58
    v_exp_f32 v59, v59
    v_cvt_pk_bf16_f32 v76, v56, v57
    v_cvt_pk_bf16_f32 v77, v58, v59
    v_mfma_f32_32x32x16_bf16 v[16:31], v[100:103], v[68:71], v[16:31]
    v_exp_f32 v60, v60
    v_exp_f32 v61, v61
    v_exp_f32 v62, v62
    v_exp_f32 v63, v63
    v_cvt_pk_bf16_f32 v78, v60, v61
    v_cvt_pk_bf16_f32 v79, v62, v63
    s_waitcnt lgkmcnt(0)
    v_mfma_f32_32x32x16_bf16 v[48:63], v[88:91], v[8:11], v[112:127]
    ds_read_b128 v[80:83], v4 offset:40960
    ds_read_b128 v[84:87], v4 offset:41984
    v_exp_f32 v32, v32
    v_exp_f32 v33, v33
    v_exp_f32 v34, v34
    v_exp_f32 v35, v35
    v_cvt_pk_bf16_f32 v64, v32, v33
    v_cvt_pk_bf16_f32 v65, v34, v35
    v_mfma_f32_32x32x16_bf16 v[16:31], v[104:107], v[72:75], v[16:31]
    ds_read_b128 v[96:99], v4 offset:53248
    ds_read_b128 v[100:103], v4 offset:54272
    v_exp_f32 v36, v36
    v_exp_f32 v37, v37
    v_exp_f32 v38, v38
    v_exp_f32 v39, v39
    v_cvt_pk_bf16_f32 v66, v36, v37
    v_cvt_pk_bf16_f32 v67, v38, v39
    v_mfma_f32_32x32x16_bf16 v[48:63], v[92:95], v[12:15], v[48:63]
    v_exp_f32 v40, v40
    v_exp_f32 v41, v41
    v_exp_f32 v42, v42
    v_exp_f32 v43, v43
    v_cvt_pk_bf16_f32 v68, v40, v41
    v_cvt_pk_bf16_f32 v69, v42, v43
    v_mfma_f32_32x32x16_bf16 v[16:31], v[108:111], v[76:79], v[16:31]
    v_exp_f32 v44, v44
    v_exp_f32 v45, v45
    v_exp_f32 v46, v46
    v_exp_f32 v47, v47
    v_cvt_pk_bf16_f32 v70, v44, v45
    v_cvt_pk_bf16_f32 v71, v46, v47
    s_waitcnt lgkmcnt(0)
    v_mfma_f32_32x32x16_bf16 v[32:47], v[80:83], v[8:11], v[112:127]
    ds_read_b128 v[88:91], v4 offset:43008
    ds_read_b128 v[92:95], v4 offset:44032
    v_exp_f32 v48, v48
    v_exp_f32 v49, v49
    v_exp_f32 v50, v50
    v_exp_f32 v51, v51
    v_cvt_pk_bf16_f32 v72, v48, v49
    v_cvt_pk_bf16_f32 v73, v50, v51
    v_mfma_f32_32x32x16_bf16 v[16:31], v[96:99], v[64:67], v[16:31]
    ds_read_b128 v[104:107], v4 offset:55296
    ds_read_b128 v[108:111], v4 offset:56320
    v_exp_f32 v52, v52
    v_exp_f32 v53, v53
    v_exp_f32 v54, v54
    v_exp_f32 v55, v55
    v_cvt_pk_bf16_f32 v74, v52, v53
    v_cvt_pk_bf16_f32 v75, v54, v55
    v_mfma_f32_32x32x16_bf16 v[32:47], v[84:87], v[12:15], v[32:47]
    v_exp_f32 v56, v56
    v_exp_f32 v57, v57
    v_exp_f32 v58, v58
    v_exp_f32 v59, v59
    v_cvt_pk_bf16_f32 v76, v56, v57
    v_cvt_pk_bf16_f32 v77, v58, v59
    v_mfma_f32_32x32x16_bf16 v[16:31], v[100:103], v[68:71], v[16:31]
    v_exp_f32 v60, v60
    v_exp_f32 v61, v61
    v_exp_f32 v62, v62
    v_exp_f32 v63, v63
    v_cvt_pk_bf16_f32 v78, v60, v61
    v_cvt_pk_bf16_f32 v79, v62, v63
    s_waitcnt lgkmcnt(0)
    v_mfma_f32_32x32x16_bf16 v[48:63], v[88:91], v[8:11], v[112:127]
    ds_read_b128 v[80:83], v4 offset:45056
    ds_read_b128 v[84:87], v4 offset:46080
    v_exp_f32 v32, v32
    v_exp_f32 v33, v33
    v_exp_f32 v34, v34
    v_exp_f32 v35, v35
    v_cvt_pk_bf16_f32 v64, v32, v33
    v_cvt_pk_bf16_f32 v65, v34, v35
    v_mfma_f32_32x32x16_bf16 v[16:31], v[104:107], v[72:75], v[16:31]
    ds_read_b128 v[96:99], v4 offset:57344
    ds_read_b128 v[100:103], v4 offset:58368
    v_exp_f32 v36, v36
    v_exp_f32 v37, v37
    v_exp_f32 v38, v38
    v_exp_f32 v39, v39
    v_cvt_pk_bf16_f32 v66, v36, v37
    v_cvt_pk_bf16_f32 v67, v38, v39
    v_mfma_f32_32x32x16_bf16 v[48:63], v[92:95], v[12:15], v[48:63]
    v_exp_f32 v40, v40
    v_exp_f32 v41, v41
    v_exp_f32 v42, v42
    v_exp_f32 v43, v43
    v_cvt_pk_bf16_f32 v68, v40, v41
    v_cvt_pk_bf16_f32 v69, v42, v43
    v_mfma_f32_32x32x16_bf16 v[16:31], v[108:111], v[76:79], v[16:31]
    v_exp_f32 v44, v44
    v_exp_f32 v45, v45
    v_exp_f32 v46, v46
    v_exp_f32 v47, v47
    v_cvt_pk_bf16_f32 v70, v44, v45
    v_cvt_pk_bf16_f32 v71, v46, v47
    s_waitcnt lgkmcnt(0)
    v_mfma_f32_32x32x16_bf16 v[32:47], v[80:83], v[8:11], v[112:127]
    ds_read_b128 v[88:91], v4 offset:47104
    ds_read_b128 v[92:95], v4 offset:48128
    v_exp_f32 v48, v48
    v_exp_f32 v49, v49
    v_exp_f32 v50, v50
    v_exp_f32 v51, v51
    v_cvt_pk_bf16_f32 v72, v48, v49
    v_cvt_pk_bf16_f32 v73, v50, v51
    v_mfma_f32_32x32x16_bf16 v[16:31], v[96:99], v[64:67], v[16:31]
    ds_read_b128 v[104:107], v4 offset:59392
    ds_read_b128 v[108:111], v4 offset:60416
    v_exp_f32 v52, v52
    v_exp_f32 v53, v53
    v_exp_f32 v54, v54
    v_exp_f32 v55, v55
    v_cvt_pk_bf16_f32 v74, v52, v53
    v_cvt_pk_bf16_f32 v75, v54, v55
    v_mfma_f32_32x32x16_bf16 v[32:47], v[84:87], v[12:15], v[32:47]
    v_exp_f32 v56, v56
    v_exp_f32 v57, v57
    v_exp_f32 v58, v58
    v_exp_f32 v59, v59
    v_cvt_pk_bf16_f32 v76, v56, v57
    v_cvt_pk_bf16_f32 v77, v58, v59
    v_mfma_f32_32x32x16_bf16 v[16:31], v[100:103], v[68:71], v[16:31]
    v_exp_f32 v60, v60
    v_exp_f32 v61, v61
    v_exp_f32 v62, v62
    v_exp_f32 v63, v63
    v_cvt_pk_bf16_f32 v78, v60, v61
    v_cvt_pk_bf16_f32 v79, v62, v63
    s_waitcnt vmcnt(8) lgkmcnt(0)
    s_barrier
    v_mfma_f32_32x32x16_bf16 v[48:63], v[88:91], v[8:11], v[112:127]
    ds_read_b128 v[80:83], v3 offset:0
    ds_read_b128 v[84:87], v3 offset:1024
    v_exp_f32 v32, v32
    v_exp_f32 v33, v33
    v_exp_f32 v34, v34
    v_exp_f32 v35, v35
    v_cvt_pk_bf16_f32 v64, v32, v33
    v_cvt_pk_bf16_f32 v65, v34, v35
    v_mfma_f32_32x32x16_bf16 v[16:31], v[104:107], v[72:75], v[16:31]
    ds_read_b128 v[96:99], v4 offset:61440
    ds_read_b128 v[100:103], v4 offset:62464
    s_add_u32 s71, s69, 65536
    s_mov_b32 m0, s71
    s_add_u32 s72, s70, 98304
    buffer_load_dwordx4 v3, s[48:51], s72 offen offset:0 lds
    v_exp_f32 v36, v36
    v_exp_f32 v37, v37
    v_exp_f32 v38, v38
    v_exp_f32 v39, v39
    v_cvt_pk_bf16_f32 v66, v36, v37
    v_cvt_pk_bf16_f32 v67, v38, v39
    v_mfma_f32_32x32x16_bf16 v[48:63], v[92:95], v[12:15], v[48:63]
    buffer_load_dwordx4 v3, s[48:51], s72 offen offset:1024 lds
    v_exp_f32 v40, v40
    v_exp_f32 v41, v41
    v_exp_f32 v42, v42
    v_exp_f32 v43, v43
    v_cvt_pk_bf16_f32 v68, v40, v41
    v_cvt_pk_bf16_f32 v69, v42, v43
    v_mfma_f32_32x32x16_bf16 v[16:31], v[108:111], v[76:79], v[16:31]
    v_exp_f32 v44, v44
    v_exp_f32 v45, v45
    v_exp_f32 v46, v46
    v_exp_f32 v47, v47
    v_cvt_pk_bf16_f32 v70, v44, v45
    v_cvt_pk_bf16_f32 v71, v46, v47
    s_waitcnt lgkmcnt(0)
    v_mfma_f32_32x32x16_bf16 v[32:47], v[80:83], v[8:11], v[112:127]
    ds_read_b128 v[88:91], v3 offset:2048
    ds_read_b128 v[92:95], v3 offset:3072
    v_exp_f32 v48, v48
    v_exp_f32 v49, v49
    v_exp_f32 v50, v50
    v_exp_f32 v51, v51
    v_cvt_pk_bf16_f32 v72, v48, v49
    v_cvt_pk_bf16_f32 v73, v50, v51
    v_mfma_f32_32x32x16_bf16 v[16:31], v[96:99], v[64:67], v[16:31]
    ds_read_b128 v[104:107], v4 offset:63488
    ds_read_b128 v[108:111], v4 offset:64512
    buffer_load_dwordx4 v3, s[48:51], s72 offen offset:2048 lds
    v_exp_f32 v52, v52
    v_exp_f32 v53, v53
    v_exp_f32 v54, v54
    v_exp_f32 v55, v55
    v_cvt_pk_bf16_f32 v74, v52, v53
    v_cvt_pk_bf16_f32 v75, v54, v55
    v_mfma_f32_32x32x16_bf16 v[32:47], v[84:87], v[12:15], v[32:47]
    buffer_load_dwordx4 v3, s[48:51], s72 offen offset:3072 lds
    v_exp_f32 v56, v56
    v_exp_f32 v57, v57
    v_exp_f32 v58, v58
    v_exp_f32 v59, v59
    v_cvt_pk_bf16_f32 v76, v56, v57
    v_cvt_pk_bf16_f32 v77, v58, v59
    v_mfma_f32_32x32x16_bf16 v[16:31], v[100:103], v[68:71], v[16:31]
    v_exp_f32 v60, v60
    v_exp_f32 v61, v61
    v_exp_f32 v62, v62
    v_exp_f32 v63, v63
    v_cvt_pk_bf16_f32 v78, v60, v61
    v_cvt_pk_bf16_f32 v79, v62, v63
    s_waitcnt lgkmcnt(0)
    v_mfma_f32_32x32x16_bf16 v[48:63], v[88:91], v[8:11], v[112:127]
    ds_read_b128 v[80:83], v3 offset:4096
    ds_read_b128 v[84:87], v3 offset:5120
    v_exp_f32 v32, v32
    v_exp_f32 v33, v33
    v_exp_f32 v34, v34
    v_exp_f32 v35, v35
    v_cvt_pk_bf16_f32 v64, v32, v33
    v_cvt_pk_bf16_f32 v65, v34, v35
    v_mfma_f32_32x32x16_bf16 v[16:31], v[104:107], v[72:75], v[16:31]
    ds_read_b128 v[96:99], v3 offset:16384
    ds_read_b128 v[100:103], v3 offset:17408
    s_add_u32 s71, s69, 81920
    s_mov_b32 m0, s71
    s_add_u32 s72, s70, 98304
    buffer_load_dwordx4 v3, s[52:55], s72 offen offset:0 lds
    v_exp_f32 v36, v36
    v_exp_f32 v37, v37
    v_exp_f32 v38, v38
    v_exp_f32 v39, v39
    v_cvt_pk_bf16_f32 v66, v36, v37
    v_cvt_pk_bf16_f32 v67, v38, v39
    v_mfma_f32_32x32x16_bf16 v[48:63], v[92:95], v[12:15], v[48:63]
    buffer_load_dwordx4 v3, s[52:55], s72 offen offset:1024 lds
    v_exp_f32 v40, v40
    v_exp_f32 v41, v41
    v_exp_f32 v42, v42
    v_exp_f32 v43, v43
    v_cvt_pk_bf16_f32 v68, v40, v41
    v_cvt_pk_bf16_f32 v69, v42, v43
    v_mfma_f32_32x32x16_bf16 v[16:31], v[108:111], v[76:79], v[16:31]
    v_exp_f32 v44, v44
    v_exp_f32 v45, v45
    v_exp_f32 v46, v46
    v_exp_f32 v47, v47
    v_cvt_pk_bf16_f32 v70, v44, v45
    v_cvt_pk_bf16_f32 v71, v46, v47
    s_waitcnt lgkmcnt(0)
    v_mfma_f32_32x32x16_bf16 v[32:47], v[80:83], v[8:11], v[112:127]
    ds_read_b128 v[88:91], v3 offset:6144
    ds_read_b128 v[92:95], v3 offset:7168
    v_exp_f32 v48, v48
    v_exp_f32 v49, v49
    v_exp_f32 v50, v50
    v_exp_f32 v51, v51
    v_cvt_pk_bf16_f32 v72, v48, v49
    v_cvt_pk_bf16_f32 v73, v50, v51
    v_mfma_f32_32x32x16_bf16 v[16:31], v[96:99], v[64:67], v[16:31]
    ds_read_b128 v[104:107], v3 offset:18432
    ds_read_b128 v[108:111], v3 offset:19456
    buffer_load_dwordx4 v3, s[52:55], s72 offen offset:2048 lds
    v_exp_f32 v52, v52
    v_exp_f32 v53, v53
    v_exp_f32 v54, v54
    v_exp_f32 v55, v55
    v_cvt_pk_bf16_f32 v74, v52, v53
    v_cvt_pk_bf16_f32 v75, v54, v55
    v_mfma_f32_32x32x16_bf16 v[32:47], v[84:87], v[12:15], v[32:47]
    buffer_load_dwordx4 v3, s[52:55], s72 offen offset:3072 lds
    v_exp_f32 v56, v56
    v_exp_f32 v57, v57
    v_exp_f32 v58, v58
    v_exp_f32 v59, v59
    v_cvt_pk_bf16_f32 v76, v56, v57
    v_cvt_pk_bf16_f32 v77, v58, v59
    v_mfma_f32_32x32x16_bf16 v[16:31], v[100:103], v[68:71], v[16:31]
    v_exp_f32 v60, v60
    v_exp_f32 v61, v61
    v_exp_f32 v62, v62
    v_exp_f32 v63, v63
    v_cvt_pk_bf16_f32 v78, v60, v61
    v_cvt_pk_bf16_f32 v79, v62, v63
    s_waitcnt lgkmcnt(0)
    v_mfma_f32_32x32x16_bf16 v[48:63], v[88:91], v[8:11], v[112:127]
    ds_read_b128 v[80:83], v3 offset:8192
    ds_read_b128 v[84:87], v3 offset:9216
    v_exp_f32 v32, v32
    v_exp_f32 v33, v33
    v_exp_f32 v34, v34
    v_exp_f32 v35, v35
    v_cvt_pk_bf16_f32 v64, v32, v33
    v_cvt_pk_bf16_f32 v65, v34, v35
    v_mfma_f32_32x32x16_bf16 v[16:31], v[104:107], v[72:75], v[16:31]
    ds_read_b128 v[96:99], v3 offset:20480
    ds_read_b128 v[100:103], v3 offset:21504
    v_exp_f32 v36, v36
    v_exp_f32 v37, v37
    v_exp_f32 v38, v38
    v_exp_f32 v39, v39
    v_cvt_pk_bf16_f32 v66, v36, v37
    v_cvt_pk_bf16_f32 v67, v38, v39
    v_mfma_f32_32x32x16_bf16 v[48:63], v[92:95], v[12:15], v[48:63]
    v_exp_f32 v40, v40
    v_exp_f32 v41, v41
    v_exp_f32 v42, v42
    v_exp_f32 v43, v43
    v_cvt_pk_bf16_f32 v68, v40, v41
    v_cvt_pk_bf16_f32 v69, v42, v43
    v_mfma_f32_32x32x16_bf16 v[16:31], v[108:111], v[76:79], v[16:31]
    v_exp_f32 v44, v44
    v_exp_f32 v45, v45
    v_exp_f32 v46, v46
    v_exp_f32 v47, v47
    v_cvt_pk_bf16_f32 v70, v44, v45
    v_cvt_pk_bf16_f32 v71, v46, v47
    s_waitcnt lgkmcnt(0)
    v_mfma_f32_32x32x16_bf16 v[32:47], v[80:83], v[8:11], v[112:127]
    ds_read_b128 v[88:91], v3 offset:10240
    ds_read_b128 v[92:95], v3 offset:11264
    v_exp_f32 v48, v48
    v_exp_f32 v49, v49
    v_exp_f32 v50, v50
    v_exp_f32 v51, v51
    v_cvt_pk_bf16_f32 v72, v48, v49
    v_cvt_pk_bf16_f32 v73, v50, v51
    v_mfma_f32_32x32x16_bf16 v[16:31], v[96:99], v[64:67], v[16:31]
    ds_read_b128 v[104:107], v3 offset:22528
    ds_read_b128 v[108:111], v3 offset:23552
    v_exp_f32 v52, v52
    v_exp_f32 v53, v53
    v_exp_f32 v54, v54
    v_exp_f32 v55, v55
    v_cvt_pk_bf16_f32 v74, v52, v53
    v_cvt_pk_bf16_f32 v75, v54, v55
    v_mfma_f32_32x32x16_bf16 v[32:47], v[84:87], v[12:15], v[32:47]
    v_exp_f32 v56, v56
    v_exp_f32 v57, v57
    v_exp_f32 v58, v58
    v_exp_f32 v59, v59
    v_cvt_pk_bf16_f32 v76, v56, v57
    v_cvt_pk_bf16_f32 v77, v58, v59
    v_mfma_f32_32x32x16_bf16 v[16:31], v[100:103], v[68:71], v[16:31]
    v_exp_f32 v60, v60
    v_exp_f32 v61, v61
    v_exp_f32 v62, v62
    v_exp_f32 v63, v63
    v_cvt_pk_bf16_f32 v78, v60, v61
    v_cvt_pk_bf16_f32 v79, v62, v63
    s_waitcnt lgkmcnt(0)
    v_mfma_f32_32x32x16_bf16 v[48:63], v[88:91], v[8:11], v[112:127]
    ds_read_b128 v[80:83], v3 offset:12288
    ds_read_b128 v[84:87], v3 offset:13312
    v_exp_f32 v32, v32
    v_exp_f32 v33, v33
    v_exp_f32 v34, v34
    v_exp_f32 v35, v35
    v_cvt_pk_bf16_f32 v64, v32, v33
    v_cvt_pk_bf16_f32 v65, v34, v35
    v_mfma_f32_32x32x16_bf16 v[16:31], v[104:107], v[72:75], v[16:31]
    ds_read_b128 v[96:99], v3 offset:24576
    ds_read_b128 v[100:103], v3 offset:25600
    v_exp_f32 v36, v36
    v_exp_f32 v37, v37
    v_exp_f32 v38, v38
    v_exp_f32 v39, v39
    v_cvt_pk_bf16_f32 v66, v36, v37
    v_cvt_pk_bf16_f32 v67, v38, v39
    v_mfma_f32_32x32x16_bf16 v[48:63], v[92:95], v[12:15], v[48:63]
    v_exp_f32 v40, v40
    v_exp_f32 v41, v41
    v_exp_f32 v42, v42
    v_exp_f32 v43, v43
    v_cvt_pk_bf16_f32 v68, v40, v41
    v_cvt_pk_bf16_f32 v69, v42, v43
    v_mfma_f32_32x32x16_bf16 v[16:31], v[108:111], v[76:79], v[16:31]
    v_exp_f32 v44, v44
    v_exp_f32 v45, v45
    v_exp_f32 v46, v46
    v_exp_f32 v47, v47
    v_cvt_pk_bf16_f32 v70, v44, v45
    v_cvt_pk_bf16_f32 v71, v46, v47
    s_waitcnt lgkmcnt(0)
    v_mfma_f32_32x32x16_bf16 v[32:47], v[80:83], v[8:11], v[112:127]
    ds_read_b128 v[88:91], v3 offset:14336
    ds_read_b128 v[92:95], v3 offset:15360
    v_exp_f32 v48, v48
    v_exp_f32 v49, v49
    v_exp_f32 v50, v50
    v_exp_f32 v51, v51
    v_cvt_pk_bf16_f32 v72, v48, v49
    v_cvt_pk_bf16_f32 v73, v50, v51
    v_mfma_f32_32x32x16_bf16 v[16:31], v[96:99], v[64:67], v[16:31]
    ds_read_b128 v[104:107], v3 offset:26624
    ds_read_b128 v[108:111], v3 offset:27648
    v_exp_f32 v52, v52
    v_exp_f32 v53, v53
    v_exp_f32 v54, v54
    v_exp_f32 v55, v55
    v_cvt_pk_bf16_f32 v74, v52, v53
    v_cvt_pk_bf16_f32 v75, v54, v55
    v_mfma_f32_32x32x16_bf16 v[32:47], v[84:87], v[12:15], v[32:47]
    v_exp_f32 v56, v56
    v_exp_f32 v57, v57
    v_exp_f32 v58, v58
    v_exp_f32 v59, v59
    v_cvt_pk_bf16_f32 v76, v56, v57
    v_cvt_pk_bf16_f32 v77, v58, v59
    v_mfma_f32_32x32x16_bf16 v[16:31], v[100:103], v[68:71], v[16:31]
    v_exp_f32 v60, v60
    v_exp_f32 v61, v61
    v_exp_f32 v62, v62
    v_exp_f32 v63, v63
    v_cvt_pk_bf16_f32 v78, v60, v61
    v_cvt_pk_bf16_f32 v79, v62, v63
    s_waitcnt vmcnt(8) lgkmcnt(0)
    s_barrier
    v_mfma_f32_32x32x16_bf16 v[48:63], v[88:91], v[8:11], v[112:127]
    ds_read_b128 v[80:83], v3 offset:32768
    ds_read_b128 v[84:87], v3 offset:33792
    v_exp_f32 v32, v32
    v_exp_f32 v33, v33
    v_exp_f32 v34, v34
    v_exp_f32 v35, v35
    v_cvt_pk_bf16_f32 v64, v32, v33
    v_cvt_pk_bf16_f32 v65, v34, v35
    v_mfma_f32_32x32x16_bf16 v[16:31], v[104:107], v[72:75], v[16:31]
    ds_read_b128 v[96:99], v3 offset:28672
    ds_read_b128 v[100:103], v3 offset:29696
    s_add_u32 s71, s69, 98304
    s_mov_b32 m0, s71
    s_add_u32 s72, s70, 114688
    buffer_load_dwordx4 v3, s[48:51], s72 offen offset:0 lds
    v_exp_f32 v36, v36
    v_exp_f32 v37, v37
    v_exp_f32 v38, v38
    v_exp_f32 v39, v39
    v_cvt_pk_bf16_f32 v66, v36, v37
    v_cvt_pk_bf16_f32 v67, v38, v39
    v_mfma_f32_32x32x16_bf16 v[48:63], v[92:95], v[12:15], v[48:63]
    buffer_load_dwordx4 v3, s[48:51], s72 offen offset:1024 lds
    v_exp_f32 v40, v40
    v_exp_f32 v41, v41
    v_exp_f32 v42, v42
    v_exp_f32 v43, v43
    v_cvt_pk_bf16_f32 v68, v40, v41
    v_cvt_pk_bf16_f32 v69, v42, v43
    v_mfma_f32_32x32x16_bf16 v[16:31], v[108:111], v[76:79], v[16:31]
    v_exp_f32 v44, v44
    v_exp_f32 v45, v45
    v_exp_f32 v46, v46
    v_exp_f32 v47, v47
    v_cvt_pk_bf16_f32 v70, v44, v45
    v_cvt_pk_bf16_f32 v71, v46, v47
    s_waitcnt lgkmcnt(0)
    v_mfma_f32_32x32x16_bf16 v[32:47], v[80:83], v[8:11], v[112:127]
    ds_read_b128 v[88:91], v3 offset:34816
    ds_read_b128 v[92:95], v3 offset:35840
    v_exp_f32 v48, v48
    v_exp_f32 v49, v49
    v_exp_f32 v50, v50
    v_exp_f32 v51, v51
    v_cvt_pk_bf16_f32 v72, v48, v49
    v_cvt_pk_bf16_f32 v73, v50, v51
    v_mfma_f32_32x32x16_bf16 v[16:31], v[96:99], v[64:67], v[16:31]
    ds_read_b128 v[104:107], v3 offset:30720
    ds_read_b128 v[108:111], v3 offset:31744
    buffer_load_dwordx4 v3, s[48:51], s72 offen offset:2048 lds
    v_exp_f32 v52, v52
    v_exp_f32 v53, v53
    v_exp_f32 v54, v54
    v_exp_f32 v55, v55
    v_cvt_pk_bf16_f32 v74, v52, v53
    v_cvt_pk_bf16_f32 v75, v54, v55
    v_mfma_f32_32x32x16_bf16 v[32:47], v[84:87], v[12:15], v[32:47]
    buffer_load_dwordx4 v3, s[48:51], s72 offen offset:3072 lds
    v_exp_f32 v56, v56
    v_exp_f32 v57, v57
    v_exp_f32 v58, v58
    v_exp_f32 v59, v59
    v_cvt_pk_bf16_f32 v76, v56, v57
    v_cvt_pk_bf16_f32 v77, v58, v59
    v_mfma_f32_32x32x16_bf16 v[16:31], v[100:103], v[68:71], v[16:31]
    v_exp_f32 v60, v60
    v_exp_f32 v61, v61
    v_exp_f32 v62, v62
    v_exp_f32 v63, v63
    v_cvt_pk_bf16_f32 v78, v60, v61
    v_cvt_pk_bf16_f32 v79, v62, v63
    s_waitcnt lgkmcnt(0)
    v_mfma_f32_32x32x16_bf16 v[48:63], v[88:91], v[8:11], v[112:127]
    ds_read_b128 v[80:83], v3 offset:36864
    ds_read_b128 v[84:87], v3 offset:37888
    v_exp_f32 v32, v32
    v_exp_f32 v33, v33
    v_exp_f32 v34, v34
    v_exp_f32 v35, v35
    v_cvt_pk_bf16_f32 v64, v32, v33
    v_cvt_pk_bf16_f32 v65, v34, v35
    v_mfma_f32_32x32x16_bf16 v[16:31], v[104:107], v[72:75], v[16:31]
    ds_read_b128 v[96:99], v3 offset:49152
    ds_read_b128 v[100:103], v3 offset:50176
    s_add_u32 s71, s69, 114688
    s_mov_b32 m0, s71
    s_add_u32 s72, s70, 114688
    buffer_load_dwordx4 v3, s[52:55], s72 offen offset:0 lds
    v_exp_f32 v36, v36
    v_exp_f32 v37, v37
    v_exp_f32 v38, v38
    v_exp_f32 v39, v39
    v_cvt_pk_bf16_f32 v66, v36, v37
    v_cvt_pk_bf16_f32 v67, v38, v39
    v_mfma_f32_32x32x16_bf16 v[48:63], v[92:95], v[12:15], v[48:63]
    buffer_load_dwordx4 v3, s[52:55], s72 offen offset:1024 lds
    v_exp_f32 v40, v40
    v_exp_f32 v41, v41
    v_exp_f32 v42, v42
    v_exp_f32 v43, v43
    v_cvt_pk_bf16_f32 v68, v40, v41
    v_cvt_pk_bf16_f32 v69, v42, v43
    v_mfma_f32_32x32x16_bf16 v[16:31], v[108:111], v[76:79], v[16:31]
    v_exp_f32 v44, v44
    v_exp_f32 v45, v45
    v_exp_f32 v46, v46
    v_exp_f32 v47, v47
    v_cvt_pk_bf16_f32 v70, v44, v45
    v_cvt_pk_bf16_f32 v71, v46, v47
    s_waitcnt lgkmcnt(0)
    v_mfma_f32_32x32x16_bf16 v[32:47], v[80:83], v[8:11], v[112:127]
    ds_read_b128 v[88:91], v3 offset:38912
    ds_read_b128 v[92:95], v3 offset:39936
    v_exp_f32 v48, v48
    v_exp_f32 v49, v49
    v_exp_f32 v50, v50
    v_exp_f32 v51, v51
    v_cvt_pk_bf16_f32 v72, v48, v49
    v_cvt_pk_bf16_f32 v73, v50, v51
    v_mfma_f32_32x32x16_bf16 v[16:31], v[96:99], v[64:67], v[16:31]
    ds_read_b128 v[104:107], v3 offset:51200
    ds_read_b128 v[108:111], v3 offset:52224
    buffer_load_dwordx4 v3, s[52:55], s72 offen offset:2048 lds
    v_exp_f32 v52, v52
    v_exp_f32 v53, v53
    v_exp_f32 v54, v54
    v_exp_f32 v55, v55
    v_cvt_pk_bf16_f32 v74, v52, v53
    v_cvt_pk_bf16_f32 v75, v54, v55
    v_mfma_f32_32x32x16_bf16 v[32:47], v[84:87], v[12:15], v[32:47]
    buffer_load_dwordx4 v3, s[52:55], s72 offen offset:3072 lds
    v_exp_f32 v56, v56
    v_exp_f32 v57, v57
    v_exp_f32 v58, v58
    v_exp_f32 v59, v59
    v_cvt_pk_bf16_f32 v76, v56, v57
    v_cvt_pk_bf16_f32 v77, v58, v59
    v_mfma_f32_32x32x16_bf16 v[16:31], v[100:103], v[68:71], v[16:31]
    v_exp_f32 v60, v60
    v_exp_f32 v61, v61
    v_exp_f32 v62, v62
    v_exp_f32 v63, v63
    v_cvt_pk_bf16_f32 v78, v60, v61
    v_cvt_pk_bf16_f32 v79, v62, v63
    s_waitcnt lgkmcnt(0)
    v_mfma_f32_32x32x16_bf16 v[48:63], v[88:91], v[8:11], v[112:127]
    ds_read_b128 v[80:83], v3 offset:40960
    ds_read_b128 v[84:87], v3 offset:41984
    v_exp_f32 v32, v32
    v_exp_f32 v33, v33
    v_exp_f32 v34, v34
    v_exp_f32 v35, v35
    v_cvt_pk_bf16_f32 v64, v32, v33
    v_cvt_pk_bf16_f32 v65, v34, v35
    v_mfma_f32_32x32x16_bf16 v[16:31], v[104:107], v[72:75], v[16:31]
    ds_read_b128 v[96:99], v3 offset:53248
    ds_read_b128 v[100:103], v3 offset:54272
    v_exp_f32 v36, v36
    v_exp_f32 v37, v37
    v_exp_f32 v38, v38
    v_exp_f32 v39, v39
    v_cvt_pk_bf16_f32 v66, v36, v37
    v_cvt_pk_bf16_f32 v67, v38, v39
    v_mfma_f32_32x32x16_bf16 v[48:63], v[92:95], v[12:15], v[48:63]
    v_exp_f32 v40, v40
    v_exp_f32 v41, v41
    v_exp_f32 v42, v42
    v_exp_f32 v43, v43
    v_cvt_pk_bf16_f32 v68, v40, v41
    v_cvt_pk_bf16_f32 v69, v42, v43
    v_mfma_f32_32x32x16_bf16 v[16:31], v[108:111], v[76:79], v[16:31]
    v_exp_f32 v44, v44
    v_exp_f32 v45, v45
    v_exp_f32 v46, v46
    v_exp_f32 v47, v47
    v_cvt_pk_bf16_f32 v70, v44, v45
    v_cvt_pk_bf16_f32 v71, v46, v47
    s_waitcnt lgkmcnt(0)
    v_mfma_f32_32x32x16_bf16 v[32:47], v[80:83], v[8:11], v[112:127]
    ds_read_b128 v[88:91], v3 offset:43008
    ds_read_b128 v[92:95], v3 offset:44032
    v_exp_f32 v48, v48
    v_exp_f32 v49, v49
    v_exp_f32 v50, v50
    v_exp_f32 v51, v51
    v_cvt_pk_bf16_f32 v72, v48, v49
    v_cvt_pk_bf16_f32 v73, v50, v51
    v_mfma_f32_32x32x16_bf16 v[16:31], v[96:99], v[64:67], v[16:31]
    ds_read_b128 v[104:107], v3 offset:55296
    ds_read_b128 v[108:111], v3 offset:56320
    v_exp_f32 v52, v52
    v_exp_f32 v53, v53
    v_exp_f32 v54, v54
    v_exp_f32 v55, v55
    v_cvt_pk_bf16_f32 v74, v52, v53
    v_cvt_pk_bf16_f32 v75, v54, v55
    v_mfma_f32_32x32x16_bf16 v[32:47], v[84:87], v[12:15], v[32:47]
    v_exp_f32 v56, v56
    v_exp_f32 v57, v57
    v_exp_f32 v58, v58
    v_exp_f32 v59, v59
    v_cvt_pk_bf16_f32 v76, v56, v57
    v_cvt_pk_bf16_f32 v77, v58, v59
    v_mfma_f32_32x32x16_bf16 v[16:31], v[100:103], v[68:71], v[16:31]
    v_exp_f32 v60, v60
    v_exp_f32 v61, v61
    v_exp_f32 v62, v62
    v_exp_f32 v63, v63
    v_cvt_pk_bf16_f32 v78, v60, v61
    v_cvt_pk_bf16_f32 v79, v62, v63
    s_waitcnt lgkmcnt(0)
    v_mfma_f32_32x32x16_bf16 v[48:63], v[88:91], v[8:11], v[112:127]
    ds_read_b128 v[80:83], v3 offset:45056
    ds_read_b128 v[84:87], v3 offset:46080
    v_exp_f32 v32, v32
    v_exp_f32 v33, v33
    v_exp_f32 v34, v34
    v_exp_f32 v35, v35
    v_cvt_pk_bf16_f32 v64, v32, v33
    v_cvt_pk_bf16_f32 v65, v34, v35
    v_mfma_f32_32x32x16_bf16 v[16:31], v[104:107], v[72:75], v[16:31]
    ds_read_b128 v[96:99], v3 offset:57344
    ds_read_b128 v[100:103], v3 offset:58368
    v_exp_f32 v36, v36
    v_exp_f32 v37, v37
    v_exp_f32 v38, v38
    v_exp_f32 v39, v39
    v_cvt_pk_bf16_f32 v66, v36, v37
    v_cvt_pk_bf16_f32 v67, v38, v39
    v_mfma_f32_32x32x16_bf16 v[48:63], v[92:95], v[12:15], v[48:63]
    v_exp_f32 v40, v40
    v_exp_f32 v41, v41
    v_exp_f32 v42, v42
    v_exp_f32 v43, v43
    v_cvt_pk_bf16_f32 v68, v40, v41
    v_cvt_pk_bf16_f32 v69, v42, v43
    v_mfma_f32_32x32x16_bf16 v[16:31], v[108:111], v[76:79], v[16:31]
    v_exp_f32 v44, v44
    v_exp_f32 v45, v45
    v_exp_f32 v46, v46
    v_exp_f32 v47, v47
    v_cvt_pk_bf16_f32 v70, v44, v45
    v_cvt_pk_bf16_f32 v71, v46, v47
    s_waitcnt lgkmcnt(0)
    v_mfma_f32_32x32x16_bf16 v[32:47], v[80:83], v[8:11], v[112:127]
    ds_read_b128 v[88:91], v3 offset:47104
    ds_read_b128 v[92:95], v3 offset:48128
    v_exp_f32 v48, v48
    v_exp_f32 v49, v49
    v_exp_f32 v50, v50
    v_exp_f32 v51, v51
    v_cvt_pk_bf16_f32 v72, v48, v49
    v_cvt_pk_bf16_f32 v73, v50, v51
    v_mfma_f32_32x32x16_bf16 v[16:31], v[96:99], v[64:67], v[16:31]
    ds_read_b128 v[104:107], v3 offset:59392
    ds_read_b128 v[108:111], v3 offset:60416
    v_exp_f32 v52, v52
    v_exp_f32 v53, v53
    v_exp_f32 v54, v54
    v_exp_f32 v55, v55
    v_cvt_pk_bf16_f32 v74, v52, v53
    v_cvt_pk_bf16_f32 v75, v54, v55
    v_mfma_f32_32x32x16_bf16 v[32:47], v[84:87], v[12:15], v[32:47]
    v_exp_f32 v56, v56
    v_exp_f32 v57, v57
    v_exp_f32 v58, v58
    v_exp_f32 v59, v59
    v_cvt_pk_bf16_f32 v76, v56, v57
    v_cvt_pk_bf16_f32 v77, v58, v59
    v_mfma_f32_32x32x16_bf16 v[16:31], v[100:103], v[68:71], v[16:31]
    v_exp_f32 v60, v60
    v_exp_f32 v61, v61
    v_exp_f32 v62, v62
    v_exp_f32 v63, v63
    v_cvt_pk_bf16_f32 v78, v60, v61
    v_cvt_pk_bf16_f32 v79, v62, v63
    s_waitcnt vmcnt(8) lgkmcnt(0)
    s_barrier
    v_mfma_f32_32x32x16_bf16 v[48:63], v[88:91], v[8:11], v[112:127]
    ds_read_b128 v[80:83], v4 offset:0
    ds_read_b128 v[84:87], v4 offset:1024
    v_exp_f32 v32, v32
    v_exp_f32 v33, v33
    v_exp_f32 v34, v34
    v_exp_f32 v35, v35
    v_cvt_pk_bf16_f32 v64, v32, v33
    v_cvt_pk_bf16_f32 v65, v34, v35
    v_mfma_f32_32x32x16_bf16 v[16:31], v[104:107], v[72:75], v[16:31]
    ds_read_b128 v[96:99], v3 offset:61440
    ds_read_b128 v[100:103], v3 offset:62464
    v_exp_f32 v36, v36
    v_exp_f32 v37, v37
    v_exp_f32 v38, v38
    v_exp_f32 v39, v39
    v_cvt_pk_bf16_f32 v66, v36, v37
    v_cvt_pk_bf16_f32 v67, v38, v39
    v_mfma_f32_32x32x16_bf16 v[48:63], v[92:95], v[12:15], v[48:63]
    v_exp_f32 v40, v40
    v_exp_f32 v41, v41
    v_exp_f32 v42, v42
    v_exp_f32 v43, v43
    v_cvt_pk_bf16_f32 v68, v40, v41
    v_cvt_pk_bf16_f32 v69, v42, v43
    v_mfma_f32_32x32x16_bf16 v[16:31], v[108:111], v[76:79], v[16:31]
    v_exp_f32 v44, v44
    v_exp_f32 v45, v45
    v_exp_f32 v46, v46
    v_exp_f32 v47, v47
    v_cvt_pk_bf16_f32 v70, v44, v45
    v_cvt_pk_bf16_f32 v71, v46, v47
    s_waitcnt lgkmcnt(0)
    v_mfma_f32_32x32x16_bf16 v[32:47], v[80:83], v[8:11], v[112:127]
    ds_read_b128 v[88:91], v4 offset:2048
    ds_read_b128 v[92:95], v4 offset:3072
    v_exp_f32 v48, v48
    v_exp_f32 v49, v49
    v_exp_f32 v50, v50
    v_exp_f32 v51, v51
    v_cvt_pk_bf16_f32 v72, v48, v49
    v_cvt_pk_bf16_f32 v73, v50, v51
    v_mfma_f32_32x32x16_bf16 v[16:31], v[96:99], v[64:67], v[16:31]
    ds_read_b128 v[104:107], v3 offset:63488
    ds_read_b128 v[108:111], v3 offset:64512
    v_exp_f32 v52, v52
    v_exp_f32 v53, v53
    v_exp_f32 v54, v54
    v_exp_f32 v55, v55
    v_cvt_pk_bf16_f32 v74, v52, v53
    v_cvt_pk_bf16_f32 v75, v54, v55
    v_mfma_f32_32x32x16_bf16 v[32:47], v[84:87], v[12:15], v[32:47]
    v_exp_f32 v56, v56
    v_exp_f32 v57, v57
    v_exp_f32 v58, v58
    v_exp_f32 v59, v59
    v_cvt_pk_bf16_f32 v76, v56, v57
    v_cvt_pk_bf16_f32 v77, v58, v59
    v_mfma_f32_32x32x16_bf16 v[16:31], v[100:103], v[68:71], v[16:31]
    v_exp_f32 v60, v60
    v_exp_f32 v61, v61
    v_exp_f32 v62, v62
    v_exp_f32 v63, v63
    v_cvt_pk_bf16_f32 v78, v60, v61
    v_cvt_pk_bf16_f32 v79, v62, v63
    s_waitcnt lgkmcnt(0)
    v_mfma_f32_32x32x16_bf16 v[48:63], v[88:91], v[8:11], v[112:127]
    ds_read_b128 v[80:83], v4 offset:4096
    ds_read_b128 v[84:87], v4 offset:5120
    v_exp_f32 v32, v32
    v_exp_f32 v33, v33
    v_exp_f32 v34, v34
    v_exp_f32 v35, v35
    v_cvt_pk_bf16_f32 v64, v32, v33
    v_cvt_pk_bf16_f32 v65, v34, v35
    v_mfma_f32_32x32x16_bf16 v[16:31], v[104:107], v[72:75], v[16:31]
    ds_read_b128 v[96:99], v4 offset:16384
    ds_read_b128 v[100:103], v4 offset:17408
    v_exp_f32 v36, v36
    v_exp_f32 v37, v37
    v_exp_f32 v38, v38
    v_exp_f32 v39, v39
    v_cvt_pk_bf16_f32 v66, v36, v37
    v_cvt_pk_bf16_f32 v67, v38, v39
    v_mfma_f32_32x32x16_bf16 v[48:63], v[92:95], v[12:15], v[48:63]
    v_exp_f32 v40, v40
    v_exp_f32 v41, v41
    v_exp_f32 v42, v42
    v_exp_f32 v43, v43
    v_cvt_pk_bf16_f32 v68, v40, v41
    v_cvt_pk_bf16_f32 v69, v42, v43
    v_mfma_f32_32x32x16_bf16 v[16:31], v[108:111], v[76:79], v[16:31]
    v_exp_f32 v44, v44
    v_exp_f32 v45, v45
    v_exp_f32 v46, v46
    v_exp_f32 v47, v47
    v_cvt_pk_bf16_f32 v70, v44, v45
    v_cvt_pk_bf16_f32 v71, v46, v47
    s_waitcnt lgkmcnt(0)
    v_mfma_f32_32x32x16_bf16 v[32:47], v[80:83], v[8:11], v[112:127]
    ds_read_b128 v[88:91], v4 offset:6144
    ds_read_b128 v[92:95], v4 offset:7168
    v_exp_f32 v48, v48
    v_exp_f32 v49, v49
    v_exp_f32 v50, v50
    v_exp_f32 v51, v51
    v_cvt_pk_bf16_f32 v72, v48, v49
    v_cvt_pk_bf16_f32 v73, v50, v51
    v_mfma_f32_32x32x16_bf16 v[16:31], v[96:99], v[64:67], v[16:31]
    ds_read_b128 v[104:107], v4 offset:18432
    ds_read_b128 v[108:111], v4 offset:19456
    v_exp_f32 v52, v52
    v_exp_f32 v53, v53
    v_exp_f32 v54, v54
    v_exp_f32 v55, v55
    v_cvt_pk_bf16_f32 v74, v52, v53
    v_cvt_pk_bf16_f32 v75, v54, v55
    v_mfma_f32_32x32x16_bf16 v[32:47], v[84:87], v[12:15], v[32:47]
    v_exp_f32 v56, v56
    v_exp_f32 v57, v57
    v_exp_f32 v58, v58
    v_exp_f32 v59, v59
    v_cvt_pk_bf16_f32 v76, v56, v57
    v_cvt_pk_bf16_f32 v77, v58, v59
    v_mfma_f32_32x32x16_bf16 v[16:31], v[100:103], v[68:71], v[16:31]
    v_exp_f32 v60, v60
    v_exp_f32 v61, v61
    v_exp_f32 v62, v62
    v_exp_f32 v63, v63
    v_cvt_pk_bf16_f32 v78, v60, v61
    v_cvt_pk_bf16_f32 v79, v62, v63
    s_waitcnt lgkmcnt(0)
    v_mfma_f32_32x32x16_bf16 v[48:63], v[88:91], v[8:11], v[112:127]
    ds_read_b128 v[80:83], v4 offset:8192
    ds_read_b128 v[84:87], v4 offset:9216
    v_exp_f32 v32, v32
    v_exp_f32 v33, v33
    v_exp_f32 v34, v34
    v_exp_f32 v35, v35
    v_cvt_pk_bf16_f32 v64, v32, v33
    v_cvt_pk_bf16_f32 v65, v34, v35
    v_mfma_f32_32x32x16_bf16 v[16:31], v[104:107], v[72:75], v[16:31]
    ds_read_b128 v[96:99], v4 offset:20480
    ds_read_b128 v[100:103], v4 offset:21504
    v_exp_f32 v36, v36
    v_exp_f32 v37, v37
    v_exp_f32 v38, v38
    v_exp_f32 v39, v39
    v_cvt_pk_bf16_f32 v66, v36, v37
    v_cvt_pk_bf16_f32 v67, v38, v39
    v_mfma_f32_32x32x16_bf16 v[48:63], v[92:95], v[12:15], v[48:63]
    v_exp_f32 v40, v40
    v_exp_f32 v41, v41
    v_exp_f32 v42, v42
    v_exp_f32 v43, v43
    v_cvt_pk_bf16_f32 v68, v40, v41
    v_cvt_pk_bf16_f32 v69, v42, v43
    v_mfma_f32_32x32x16_bf16 v[16:31], v[108:111], v[76:79], v[16:31]
    v_exp_f32 v44, v44
    v_exp_f32 v45, v45
    v_exp_f32 v46, v46
    v_exp_f32 v47, v47
    v_cvt_pk_bf16_f32 v70, v44, v45
    v_cvt_pk_bf16_f32 v71, v46, v47
    s_waitcnt lgkmcnt(0)
    v_mfma_f32_32x32x16_bf16 v[32:47], v[80:83], v[8:11], v[112:127]
    ds_read_b128 v[88:91], v4 offset:10240
    ds_read_b128 v[92:95], v4 offset:11264
    v_exp_f32 v48, v48
    v_exp_f32 v49, v49
    v_exp_f32 v50, v50
    v_exp_f32 v51, v51
    v_cvt_pk_bf16_f32 v72, v48, v49
    v_cvt_pk_bf16_f32 v73, v50, v51
    v_mfma_f32_32x32x16_bf16 v[16:31], v[96:99], v[64:67], v[16:31]
    ds_read_b128 v[104:107], v4 offset:22528
    ds_read_b128 v[108:111], v4 offset:23552
    v_exp_f32 v52, v52
    v_exp_f32 v53, v53
    v_exp_f32 v54, v54
    v_exp_f32 v55, v55
    v_cvt_pk_bf16_f32 v74, v52, v53
    v_cvt_pk_bf16_f32 v75, v54, v55
    v_mfma_f32_32x32x16_bf16 v[32:47], v[84:87], v[12:15], v[32:47]
    v_exp_f32 v56, v56
    v_exp_f32 v57, v57
    v_exp_f32 v58, v58
    v_exp_f32 v59, v59
    v_cvt_pk_bf16_f32 v76, v56, v57
    v_cvt_pk_bf16_f32 v77, v58, v59
    v_mfma_f32_32x32x16_bf16 v[16:31], v[100:103], v[68:71], v[16:31]
    v_exp_f32 v60, v60
    v_exp_f32 v61, v61
    v_exp_f32 v62, v62
    v_exp_f32 v63, v63
    v_cvt_pk_bf16_f32 v78, v60, v61
    v_cvt_pk_bf16_f32 v79, v62, v63
    s_waitcnt lgkmcnt(0)
    v_mfma_f32_32x32x16_bf16 v[48:63], v[88:91], v[8:11], v[112:127]
    ds_read_b128 v[80:83], v4 offset:12288
    ds_read_b128 v[84:87], v4 offset:13312
    v_exp_f32 v32, v32
    v_exp_f32 v33, v33
    v_exp_f32 v34, v34
    v_exp_f32 v35, v35
    v_cvt_pk_bf16_f32 v64, v32, v33
    v_cvt_pk_bf16_f32 v65, v34, v35
    v_mfma_f32_32x32x16_bf16 v[16:31], v[104:107], v[72:75], v[16:31]
    ds_read_b128 v[96:99], v4 offset:24576
    ds_read_b128 v[100:103], v4 offset:25600
    v_exp_f32 v36, v36
    v_exp_f32 v37, v37
    v_exp_f32 v38, v38
    v_exp_f32 v39, v39
    v_cvt_pk_bf16_f32 v66, v36, v37
    v_cvt_pk_bf16_f32 v67, v38, v39
    v_mfma_f32_32x32x16_bf16 v[48:63], v[92:95], v[12:15], v[48:63]
    v_exp_f32 v40, v40
    v_exp_f32 v41, v41
    v_exp_f32 v42, v42
    v_exp_f32 v43, v43
    v_cvt_pk_bf16_f32 v68, v40, v41
    v_cvt_pk_bf16_f32 v69, v42, v43
    v_mfma_f32_32x32x16_bf16 v[16:31], v[108:111], v[76:79], v[16:31]
    v_exp_f32 v44, v44
    v_exp_f32 v45, v45
    v_exp_f32 v46, v46
    v_exp_f32 v47, v47
    v_cvt_pk_bf16_f32 v70, v44, v45
    v_cvt_pk_bf16_f32 v71, v46, v47
    s_waitcnt lgkmcnt(0)
    v_mfma_f32_32x32x16_bf16 v[32:47], v[80:83], v[8:11], v[112:127]
    ds_read_b128 v[88:91], v4 offset:14336
    ds_read_b128 v[92:95], v4 offset:15360
    v_exp_f32 v48, v48
    v_exp_f32 v49, v49
    v_exp_f32 v50, v50
    v_exp_f32 v51, v51
    v_cvt_pk_bf16_f32 v72, v48, v49
    v_cvt_pk_bf16_f32 v73, v50, v51
    v_mfma_f32_32x32x16_bf16 v[16:31], v[96:99], v[64:67], v[16:31]
    ds_read_b128 v[104:107], v4 offset:26624
    ds_read_b128 v[108:111], v4 offset:27648
    v_exp_f32 v52, v52
    v_exp_f32 v53, v53
    v_exp_f32 v54, v54
    v_exp_f32 v55, v55
    v_cvt_pk_bf16_f32 v74, v52, v53
    v_cvt_pk_bf16_f32 v75, v54, v55
    v_mfma_f32_32x32x16_bf16 v[32:47], v[84:87], v[12:15], v[32:47]
    v_exp_f32 v56, v56
    v_exp_f32 v57, v57
    v_exp_f32 v58, v58
    v_exp_f32 v59, v59
    v_cvt_pk_bf16_f32 v76, v56, v57
    v_cvt_pk_bf16_f32 v77, v58, v59
    v_mfma_f32_32x32x16_bf16 v[16:31], v[100:103], v[68:71], v[16:31]
    v_exp_f32 v60, v60
    v_exp_f32 v61, v61
    v_exp_f32 v62, v62
    v_exp_f32 v63, v63
    v_cvt_pk_bf16_f32 v78, v60, v61
    v_cvt_pk_bf16_f32 v79, v62, v63
    s_waitcnt vmcnt(0) lgkmcnt(0)
    s_barrier
    v_mfma_f32_32x32x16_bf16 v[48:63], v[88:91], v[8:11], v[112:127]
    ds_read_b128 v[80:83], v4 offset:32768
    ds_read_b128 v[84:87], v4 offset:33792
    v_exp_f32 v32, v32
    v_exp_f32 v33, v33
    v_exp_f32 v34, v34
    v_exp_f32 v35, v35
    v_cvt_pk_bf16_f32 v64, v32, v33
    v_cvt_pk_bf16_f32 v65, v34, v35
    v_mfma_f32_32x32x16_bf16 v[16:31], v[104:107], v[72:75], v[16:31]
    ds_read_b128 v[96:99], v4 offset:28672
    ds_read_b128 v[100:103], v4 offset:29696
    v_exp_f32 v36, v36
    v_exp_f32 v37, v37
    v_exp_f32 v38, v38
    v_exp_f32 v39, v39
    v_cvt_pk_bf16_f32 v66, v36, v37
    v_cvt_pk_bf16_f32 v67, v38, v39
    v_mfma_f32_32x32x16_bf16 v[48:63], v[92:95], v[12:15], v[48:63]
    v_exp_f32 v40, v40
    v_exp_f32 v41, v41
    v_exp_f32 v42, v42
    v_exp_f32 v43, v43
    v_cvt_pk_bf16_f32 v68, v40, v41
    v_cvt_pk_bf16_f32 v69, v42, v43
    v_mfma_f32_32x32x16_bf16 v[16:31], v[108:111], v[76:79], v[16:31]
    v_exp_f32 v44, v44
    v_exp_f32 v45, v45
    v_exp_f32 v46, v46
    v_exp_f32 v47, v47
    v_cvt_pk_bf16_f32 v70, v44, v45
    v_cvt_pk_bf16_f32 v71, v46, v47
    s_waitcnt lgkmcnt(0)
    v_mfma_f32_32x32x16_bf16 v[32:47], v[80:83], v[8:11], v[112:127]
    ds_read_b128 v[88:91], v4 offset:34816
    ds_read_b128 v[92:95], v4 offset:35840
    v_exp_f32 v48, v48
    v_exp_f32 v49, v49
    v_exp_f32 v50, v50
    v_exp_f32 v51, v51
    v_cvt_pk_bf16_f32 v72, v48, v49
    v_cvt_pk_bf16_f32 v73, v50, v51
    v_mfma_f32_32x32x16_bf16 v[16:31], v[96:99], v[64:67], v[16:31]
    ds_read_b128 v[104:107], v4 offset:30720
    ds_read_b128 v[108:111], v4 offset:31744
    v_exp_f32 v52, v52
    v_exp_f32 v53, v53
    v_exp_f32 v54, v54
    v_exp_f32 v55, v55
    v_cvt_pk_bf16_f32 v74, v52, v53
    v_cvt_pk_bf16_f32 v75, v54, v55
    v_mfma_f32_32x32x16_bf16 v[32:47], v[84:87], v[12:15], v[32:47]
    v_exp_f32 v56, v56
    v_exp_f32 v57, v57
    v_exp_f32 v58, v58
    v_exp_f32 v59, v59
    v_cvt_pk_bf16_f32 v76, v56, v57
    v_cvt_pk_bf16_f32 v77, v58, v59
    v_mfma_f32_32x32x16_bf16 v[16:31], v[100:103], v[68:71], v[16:31]
    v_exp_f32 v60, v60
    v_exp_f32 v61, v61
    v_exp_f32 v62, v62
    v_exp_f32 v63, v63
    v_cvt_pk_bf16_f32 v78, v60, v61
    v_cvt_pk_bf16_f32 v79, v62, v63
    s_waitcnt lgkmcnt(0)
    v_mfma_f32_32x32x16_bf16 v[48:63], v[88:91], v[8:11], v[112:127]
    ds_read_b128 v[80:83], v4 offset:36864
    ds_read_b128 v[84:87], v4 offset:37888
    v_exp_f32 v32, v32
    v_exp_f32 v33, v33
    v_exp_f32 v34, v34
    v_exp_f32 v35, v35
    v_cvt_pk_bf16_f32 v64, v32, v33
    v_cvt_pk_bf16_f32 v65, v34, v35
    v_mfma_f32_32x32x16_bf16 v[16:31], v[104:107], v[72:75], v[16:31]
    ds_read_b128 v[96:99], v4 offset:49152
    ds_read_b128 v[100:103], v4 offset:50176
    v_exp_f32 v36, v36
    v_exp_f32 v37, v37
    v_exp_f32 v38, v38
    v_exp_f32 v39, v39
    v_cvt_pk_bf16_f32 v66, v36, v37
    v_cvt_pk_bf16_f32 v67, v38, v39
    v_mfma_f32_32x32x16_bf16 v[48:63], v[92:95], v[12:15], v[48:63]
    v_exp_f32 v40, v40
    v_exp_f32 v41, v41
    v_exp_f32 v42, v42
    v_exp_f32 v43, v43
    v_cvt_pk_bf16_f32 v68, v40, v41
    v_cvt_pk_bf16_f32 v69, v42, v43
    v_mfma_f32_32x32x16_bf16 v[16:31], v[108:111], v[76:79], v[16:31]
    v_exp_f32 v44, v44
    v_exp_f32 v45, v45
    v_exp_f32 v46, v46
    v_exp_f32 v47, v47
    v_cvt_pk_bf16_f32 v70, v44, v45
    v_cvt_pk_bf16_f32 v71, v46, v47
    s_waitcnt lgkmcnt(0)
    v_mfma_f32_32x32x16_bf16 v[32:47], v[80:83], v[8:11], v[112:127]
    ds_read_b128 v[88:91], v4 offset:38912
    ds_read_b128 v[92:95], v4 offset:39936
    v_exp_f32 v48, v48
    v_exp_f32 v49, v49
    v_exp_f32 v50, v50
    v_exp_f32 v51, v51
    v_cvt_pk_bf16_f32 v72, v48, v49
    v_cvt_pk_bf16_f32 v73, v50, v51
    v_mfma_f32_32x32x16_bf16 v[16:31], v[96:99], v[64:67], v[16:31]
    ds_read_b128 v[104:107], v4 offset:51200
    ds_read_b128 v[108:111], v4 offset:52224
    v_exp_f32 v52, v52
    v_exp_f32 v53, v53
    v_exp_f32 v54, v54
    v_exp_f32 v55, v55
    v_cvt_pk_bf16_f32 v74, v52, v53
    v_cvt_pk_bf16_f32 v75, v54, v55
    v_mfma_f32_32x32x16_bf16 v[32:47], v[84:87], v[12:15], v[32:47]
    v_exp_f32 v56, v56
    v_exp_f32 v57, v57
    v_exp_f32 v58, v58
    v_exp_f32 v59, v59
    v_cvt_pk_bf16_f32 v76, v56, v57
    v_cvt_pk_bf16_f32 v77, v58, v59
    v_mfma_f32_32x32x16_bf16 v[16:31], v[100:103], v[68:71], v[16:31]
    v_exp_f32 v60, v60
    v_exp_f32 v61, v61
    v_exp_f32 v62, v62
    v_exp_f32 v63, v63
    v_cvt_pk_bf16_f32 v78, v60, v61
    v_cvt_pk_bf16_f32 v79, v62, v63
    s_waitcnt lgkmcnt(0)
    v_mfma_f32_32x32x16_bf16 v[48:63], v[88:91], v[8:11], v[112:127]
    ds_read_b128 v[80:83], v4 offset:40960
    ds_read_b128 v[84:87], v4 offset:41984
    v_exp_f32 v32, v32
    v_exp_f32 v33, v33
    v_exp_f32 v34, v34
    v_exp_f32 v35, v35
    v_cvt_pk_bf16_f32 v64, v32, v33
    v_cvt_pk_bf16_f32 v65, v34, v35
    v_mfma_f32_32x32x16_bf16 v[16:31], v[104:107], v[72:75], v[16:31]
    ds_read_b128 v[96:99], v4 offset:53248
    ds_read_b128 v[100:103], v4 offset:54272
    v_exp_f32 v36, v36
    v_exp_f32 v37, v37
    v_exp_f32 v38, v38
    v_exp_f32 v39, v39
    v_cvt_pk_bf16_f32 v66, v36, v37
    v_cvt_pk_bf16_f32 v67, v38, v39
    v_mfma_f32_32x32x16_bf16 v[48:63], v[92:95], v[12:15], v[48:63]
    v_exp_f32 v40, v40
    v_exp_f32 v41, v41
    v_exp_f32 v42, v42
    v_exp_f32 v43, v43
    v_cvt_pk_bf16_f32 v68, v40, v41
    v_cvt_pk_bf16_f32 v69, v42, v43
    v_mfma_f32_32x32x16_bf16 v[16:31], v[108:111], v[76:79], v[16:31]
    v_exp_f32 v44, v44
    v_exp_f32 v45, v45
    v_exp_f32 v46, v46
    v_exp_f32 v47, v47
    v_cvt_pk_bf16_f32 v70, v44, v45
    v_cvt_pk_bf16_f32 v71, v46, v47
    s_waitcnt lgkmcnt(0)
    v_mfma_f32_32x32x16_bf16 v[32:47], v[80:83], v[8:11], v[112:127]
    ds_read_b128 v[88:91], v4 offset:43008
    ds_read_b128 v[92:95], v4 offset:44032
    v_exp_f32 v48, v48
    v_exp_f32 v49, v49
    v_exp_f32 v50, v50
    v_exp_f32 v51, v51
    v_cvt_pk_bf16_f32 v72, v48, v49
    v_cvt_pk_bf16_f32 v73, v50, v51
    v_mfma_f32_32x32x16_bf16 v[16:31], v[96:99], v[64:67], v[16:31]
    ds_read_b128 v[104:107], v4 offset:55296
    ds_read_b128 v[108:111], v4 offset:56320
    v_exp_f32 v52, v52
    v_exp_f32 v53, v53
    v_exp_f32 v54, v54
    v_exp_f32 v55, v55
    v_cvt_pk_bf16_f32 v74, v52, v53
    v_cvt_pk_bf16_f32 v75, v54, v55
    v_mfma_f32_32x32x16_bf16 v[32:47], v[84:87], v[12:15], v[32:47]
    v_exp_f32 v56, v56
    v_exp_f32 v57, v57
    v_exp_f32 v58, v58
    v_exp_f32 v59, v59
    v_cvt_pk_bf16_f32 v76, v56, v57
    v_cvt_pk_bf16_f32 v77, v58, v59
    v_mfma_f32_32x32x16_bf16 v[16:31], v[100:103], v[68:71], v[16:31]
    v_exp_f32 v60, v60
    v_exp_f32 v61, v61
    v_exp_f32 v62, v62
    v_exp_f32 v63, v63
    v_cvt_pk_bf16_f32 v78, v60, v61
    v_cvt_pk_bf16_f32 v79, v62, v63
    s_waitcnt lgkmcnt(0)
    v_mfma_f32_32x32x16_bf16 v[48:63], v[88:91], v[8:11], v[112:127]
    ds_read_b128 v[80:83], v4 offset:45056
    ds_read_b128 v[84:87], v4 offset:46080
    v_exp_f32 v32, v32
    v_exp_f32 v33, v33
    v_exp_f32 v34, v34
    v_exp_f32 v35, v35
    v_cvt_pk_bf16_f32 v64, v32, v33
    v_cvt_pk_bf16_f32 v65, v34, v35
    v_mfma_f32_32x32x16_bf16 v[16:31], v[104:107], v[72:75], v[16:31]
    ds_read_b128 v[96:99], v4 offset:57344
    ds_read_b128 v[100:103], v4 offset:58368
    v_exp_f32 v36, v36
    v_exp_f32 v37, v37
    v_exp_f32 v38, v38
    v_exp_f32 v39, v39
    v_cvt_pk_bf16_f32 v66, v36, v37
    v_cvt_pk_bf16_f32 v67, v38, v39
    v_mfma_f32_32x32x16_bf16 v[48:63], v[92:95], v[12:15], v[48:63]
    v_exp_f32 v40, v40
    v_exp_f32 v41, v41
    v_exp_f32 v42, v42
    v_exp_f32 v43, v43
    v_cvt_pk_bf16_f32 v68, v40, v41
    v_cvt_pk_bf16_f32 v69, v42, v43
    v_mfma_f32_32x32x16_bf16 v[16:31], v[108:111], v[76:79], v[16:31]
    v_exp_f32 v44, v44
    v_exp_f32 v45, v45
    v_exp_f32 v46, v46
    v_exp_f32 v47, v47
    v_cvt_pk_bf16_f32 v70, v44, v45
    v_cvt_pk_bf16_f32 v71, v46, v47
    s_waitcnt lgkmcnt(0)
    v_mfma_f32_32x32x16_bf16 v[32:47], v[80:83], v[8:11], v[112:127]
    ds_read_b128 v[88:91], v4 offset:47104
    ds_read_b128 v[92:95], v4 offset:48128
    v_exp_f32 v48, v48
    v_exp_f32 v49, v49
    v_exp_f32 v50, v50
    v_exp_f32 v51, v51
    v_cvt_pk_bf16_f32 v72, v48, v49
    v_cvt_pk_bf16_f32 v73, v50, v51
    v_mfma_f32_32x32x16_bf16 v[16:31], v[96:99], v[64:67], v[16:31]
    ds_read_b128 v[104:107], v4 offset:59392
    ds_read_b128 v[108:111], v4 offset:60416
    v_exp_f32 v52, v52
    v_exp_f32 v53, v53
    v_exp_f32 v54, v54
    v_exp_f32 v55, v55
    v_cvt_pk_bf16_f32 v74, v52, v53
    v_cvt_pk_bf16_f32 v75, v54, v55
    v_mfma_f32_32x32x16_bf16 v[32:47], v[84:87], v[12:15], v[32:47]
    v_exp_f32 v56, v56
    v_exp_f32 v57, v57
    v_exp_f32 v58, v58
    v_exp_f32 v59, v59
    v_cvt_pk_bf16_f32 v76, v56, v57
    v_cvt_pk_bf16_f32 v77, v58, v59
    v_mfma_f32_32x32x16_bf16 v[16:31], v[100:103], v[68:71], v[16:31]
    v_exp_f32 v60, v60
    v_exp_f32 v61, v61
    v_exp_f32 v62, v62
    v_exp_f32 v63, v63
    v_cvt_pk_bf16_f32 v78, v60, v61
    v_cvt_pk_bf16_f32 v79, v62, v63
    s_waitcnt lgkmcnt(0)
    v_mfma_f32_32x32x16_bf16 v[48:63], v[88:91], v[8:11], v[112:127]
    v_exp_f32 v32, v32
    v_exp_f32 v33, v33
    v_exp_f32 v34, v34
    v_exp_f32 v35, v35
    v_cvt_pk_bf16_f32 v64, v32, v33
    v_cvt_pk_bf16_f32 v65, v34, v35
    v_mfma_f32_32x32x16_bf16 v[16:31], v[104:107], v[72:75], v[16:31]
    ds_read_b128 v[96:99], v4 offset:61440
    ds_read_b128 v[100:103], v4 offset:62464
    v_exp_f32 v36, v36
    v_exp_f32 v37, v37
    v_exp_f32 v38, v38
    v_exp_f32 v39, v39
    v_cvt_pk_bf16_f32 v66, v36, v37
    v_cvt_pk_bf16_f32 v67, v38, v39
    v_mfma_f32_32x32x16_bf16 v[48:63], v[92:95], v[12:15], v[48:63]
    v_exp_f32 v40, v40
    v_exp_f32 v41, v41
    v_exp_f32 v42, v42
    v_exp_f32 v43, v43
    v_cvt_pk_bf16_f32 v68, v40, v41
    v_cvt_pk_bf16_f32 v69, v42, v43
    v_mfma_f32_32x32x16_bf16 v[16:31], v[108:111], v[76:79], v[16:31]
    v_exp_f32 v44, v44
    v_exp_f32 v45, v45
    v_exp_f32 v46, v46
    v_exp_f32 v47, v47
    v_cvt_pk_bf16_f32 v70, v44, v45
    v_cvt_pk_bf16_f32 v71, v46, v47
    s_waitcnt lgkmcnt(0)
    v_exp_f32 v48, v48
    v_exp_f32 v49, v49
    v_exp_f32 v50, v50
    v_exp_f32 v51, v51
    v_cvt_pk_bf16_f32 v72, v48, v49
    v_cvt_pk_bf16_f32 v73, v50, v51
    v_mfma_f32_32x32x16_bf16 v[16:31], v[96:99], v[64:67], v[16:31]
    ds_read_b128 v[104:107], v4 offset:63488
    ds_read_b128 v[108:111], v4 offset:64512
    v_exp_f32 v52, v52
    v_exp_f32 v53, v53
    v_exp_f32 v54, v54
    v_exp_f32 v55, v55
    v_cvt_pk_bf16_f32 v74, v52, v53
    v_cvt_pk_bf16_f32 v75, v54, v55
    v_exp_f32 v56, v56
    v_exp_f32 v57, v57
    v_exp_f32 v58, v58
    v_exp_f32 v59, v59
    v_cvt_pk_bf16_f32 v76, v56, v57
    v_cvt_pk_bf16_f32 v77, v58, v59
    v_mfma_f32_32x32x16_bf16 v[16:31], v[100:103], v[68:71], v[16:31]
    v_exp_f32 v60, v60
    v_exp_f32 v61, v61
    v_exp_f32 v62, v62
    v_exp_f32 v63, v63
    v_cvt_pk_bf16_f32 v78, v60, v61
    v_cvt_pk_bf16_f32 v79, v62, v63
    s_waitcnt lgkmcnt(0)
    v_mfma_f32_32x32x16_bf16 v[16:31], v[104:107], v[72:75], v[16:31]
    v_mfma_f32_32x32x16_bf16 v[16:31], v[108:111], v[76:79], v[16:31]
    s_nop 15
    v_mov_b32 v6, v28
    v_mov_b32 v7, v28
    s_nop 1
    v_permlane32_swap_b32 v6, v7
    v_and_b32 v6, 0x7fffffff, v16
    v_add_f32 v6, v6, abs(v17)
    v_add_f32 v6, v6, abs(v18)
    v_add_f32 v6, v6, abs(v19)
    v_add_f32 v6, v6, abs(v20)
    v_add_f32 v6, v6, abs(v21)
    v_add_f32 v6, v6, abs(v22)
    v_add_f32 v6, v6, abs(v23)
    v_add_f32 v6, v6, abs(v24)
    v_add_f32 v6, v6, abs(v25)
    v_add_f32 v6, v6, abs(v26)
    v_add_f32 v6, v6, abs(v27)
    v_add_f32 v6, v6, abs(v28)
    v_add_f32 v6, v6, abs(v29)
    v_add_f32 v6, v6, abs(v30)
    v_add_f32 v6, v6, abs(v31)
    v_add_f32 v6, v6, v7
    v_mov_b32 v1, 0x7b800000
    v_cmp_nlt_f32 vcc, v6, v1
    s_nop 3
    s_cmp_eq_u64 vcc, 0
    s_cbranch_scc1 attn_kernel_ok
    v_mov_b32 v4, 131072
    v_mov_b32 v5, 1
    ds_write_b32 v4, v5
attn_kernel_ok:
    v_mov_b32 v4, 131072
    s_waitcnt lgkmcnt(0)
    s_barrier
    ds_read_b32 v5, v4
    s_waitcnt lgkmcnt(0)
    v_readfirstlane_b32 s68, v5
    s_nop 3
    s_cmp_eq_u32 s68, 0
    s_cbranch_scc1 attn_kernel_epi
    s_barrier
    s_lshl_b32 s62, s41, 17
    s_add_u32 s62, s62, s63
    s_mov_b32 s64, 0
    s_add_u32 s65, s64, s63
    s_mov_b32 m0, s65
    s_add_u32 s65, s65, 8192
    buffer_load_dwordx4 v3, s[48:51], s62 offen lds
    buffer_load_dwordx4 v3, s[48:51], s62 offen offset:1024 lds
    s_mov_b32 m0, s65
    s_add_u32 s64, s64, 16384
    buffer_load_dwordx4 v3, s[52:55], s62 offen lds
    buffer_load_dwordx4 v3, s[52:55], s62 offen offset:1024 lds
    s_add_u32 s62, s62, 8192
    s_and_b32 s64, s64, 0xffff
    s_add_u32 s65, s64, s63
    s_mov_b32 m0, s65
    s_add_u32 s65, s65, 8192
    buffer_load_dwordx4 v3, s[48:51], s62 offen lds
    buffer_load_dwordx4 v3, s[48:51], s62 offen offset:1024 lds
    s_mov_b32 m0, s65
    s_add_u32 s64, s64, 16384
    buffer_load_dwordx4 v3, s[52:55], s62 offen lds
    buffer_load_dwordx4 v3, s[52:55], s62 offen offset:1024 lds
    s_add_u32 s62, s62, 8192
    s_and_b32 s64, s64, 0xffff
    s_add_u32 s65, s64, s63
    s_mov_b32 m0, s65
    s_add_u32 s65, s65, 8192
    buffer_load_dwordx4 v3, s[48:51], s62 offen lds
    buffer_load_dwordx4 v3, s[48:51], s62 offen offset:1024 lds
    s_mov_b32 m0, s65
    s_add_u32 s64, s64, 16384
    buffer_load_dwordx4 v3, s[52:55], s62 offen lds
    buffer_load_dwordx4 v3, s[52:55], s62 offen offset:1024 lds
    s_add_u32 s62, s62, 8192
    s_and_b32 s64, s64, 0xffff
    v_mov_b32 v16, 0
    v_mov_b32 v17, 0
    v_mov_b32 v18, 0
    v_mov_b32 v19, 0
    v_mov_b32 v20, 0
    v_mov_b32 v21, 0
    v_mov_b32 v22, 0
    v_mov_b32 v23, 0
    v_mov_b32 v24, 0
    v_mov_b32 v25, 0
    v_mov_b32 v26, 0
    v_mov_b32 v27, 0
    v_mov_b32 v28, 0
    v_mov_b32 v29, 0
    v_mov_b32 v30, 0
    v_mov_b32 v31, 0
    v_mov_b32 v72, 0xff800000
    s_mov_b32 s66, 0
    s_mov_b32 s67, 0
attn_kernel_loop:
    s_cmp_ge_u32 s66, 13
    s_cbranch_scc1 attn_kernel_w0
    s_waitcnt vmcnt(8)
    s_barrier
    s_add_u32 s65, s64, s63
    s_mov_b32 m0, s65
    s_add_u32 s65, s65, 8192
    buffer_load_dwordx4 v3, s[48:51], s62 offen lds
    buffer_load_dwordx4 v3, s[48:51], s62 offen offset:1024 lds
    s_mov_b32 m0, s65
    s_add_u32 s64, s64, 16384
    buffer_load_dwordx4 v3, s[52:55], s62 offen lds
    buffer_load_dwordx4 v3, s[52:55], s62 offen offset:1024 lds
    s_add_u32 s62, s62, 8192
    s_and_b32 s64, s64, 0xffff
    s_branch attn_kernel_go
attn_kernel_w0:
    s_waitcnt vmcnt(0)
    s_barrier
attn_kernel_go:
    v_add_u32 v4, s67, v3
    ds_read_b128 v[48:51], v4 offset:0
    ds_read_b128 v[52:55], v4 offset:1024
    ds_read_b128 v[56:59], v4 offset:8192
    ds_read_b128 v[60:63], v4 offset:9216
    s_waitcnt lgkmcnt(2)
    v_mfma_f32_32x32x16_bf16 v[32:47], v[48:51], v[8:11], 0
    v_mfma_f32_32x32x16_bf16 v[32:47], v[52:55], v[12:15], v[32:47]
    s_nop 15
    v_max3_f32 v73, v32, v33, v34
    v_max3_f32 v73, v73, v35, v36
    v_max3_f32 v73, v73, v37, v38
    v_max3_f32 v73, v73, v39, v40
    v_max3_f32 v73, v73, v41, v42
    v_max3_f32 v73, v73, v43, v44
    v_max3_f32 v73, v73, v45, v46
    v_max_f32 v73, v73, v47
    v_mov_b32 v74, v73
    s_nop 1
    v_permlane32_swap_b32 v73, v74
    s_nop 1
    v_max3_f32 v73, v73, v74, v72
    v_sub_f32 v74, v72, v73
    v_exp_f32 v74, v74
    v_mov_b32 v72, v73
    v_sub_f32 v32, v32, v73
    v_sub_f32 v33, v33, v73
    v_sub_f32 v34, v34, v73
    v_sub_f32 v35, v35, v73
    v_sub_f32 v36, v36, v73
    v_sub_f32 v37, v37, v73
    v_sub_f32 v38, v38, v73
    v_sub_f32 v39, v39, v73
    v_sub_f32 v40, v40, v73
    v_sub_f32 v41, v41, v73
    v_sub_f32 v42, v42, v73
    v_sub_f32 v43, v43, v73
    v_sub_f32 v44, v44, v73
    v_sub_f32 v45, v45, v73
    v_sub_f32 v46, v46, v73
    v_sub_f32 v47, v47, v73
    v_exp_f32 v32, v32
    v_exp_f32 v33, v33
    v_exp_f32 v34, v34
    v_exp_f32 v35, v35
    v_exp_f32 v36, v36
    v_exp_f32 v37, v37
    v_exp_f32 v38, v38
    v_exp_f32 v39, v39
    v_exp_f32 v40, v40
    v_exp_f32 v41, v41
    v_exp_f32 v42, v42
    v_exp_f32 v43, v43
    v_exp_f32 v44, v44
    v_exp_f32 v45, v45
    v_exp_f32 v46, v46
    v_exp_f32 v47, v47
    v_mul_f32 v16, v16, v74
    v_mul_f32 v17, v17, v74
    v_mul_f32 v18, v18, v74
    v_mul_f32 v19, v19, v74
    v_mul_f32 v20, v20, v74
    v_mul_f32 v21, v21, v74
    v_mul_f32 v22, v22, v74
    v_mul_f32 v23, v23, v74
    v_mul_f32 v24, v24, v74
    v_mul_f32 v25, v25, v74
    v_mul_f32 v26, v26, v74
    v_mul_f32 v27, v27, v74
    v_mul_f32 v28, v28, v74
    v_mul_f32 v29, v29, v74
    v_mul_f32 v30, v30, v74
    v_mul_f32 v31, v31, v74
    v_cvt_pk_bf16_f32 v64, v32, v33
    v_cvt_pk_bf16_f32 v65, v34, v35
    v_cvt_pk_bf16_f32 v66, v36, v37
    v_cvt_pk_bf16_f32 v67, v38, v39
    v_cvt_pk_bf16_f32 v68, v40, v41
    v_cvt_pk_bf16_f32 v69, v42, v43
    v_cvt_pk_bf16_f32 v70, v44, v45
    v_cvt_pk_bf16_f32 v71, v46, v47
    s_waitcnt lgkmcnt(0)
    s_nop 1
    v_mfma_f32_32x32x16_bf16 v[16:31], v[56:59], v[64:67], v[16:31]
    v_mfma_f32_32x32x16_bf16 v[16:31], v[60:63], v[68:71], v[16:31]
    s_nop 15
    ds_read_b128 v[48:51], v4 offset:2048
    ds_read_b128 v[52:55], v4 offset:3072
    ds_read_b128 v[56:59], v4 offset:10240
    ds_read_b128 v[60:63], v4 offset:11264
    s_waitcnt lgkmcnt(2)
    v_mfma_f32_32x32x16_bf16 v[32:47], v[48:51], v[8:11], 0
    v_mfma_f32_32x32x16_bf16 v[32:47], v[52:55], v[12:15], v[32:47]
    s_nop 15
    v_max3_f32 v73, v32, v33, v34
    v_max3_f32 v73, v73, v35, v36
    v_max3_f32 v73, v73, v37, v38
    v_max3_f32 v73, v73, v39, v40
    v_max3_f32 v73, v73, v41, v42
    v_max3_f32 v73, v73, v43, v44
    v_max3_f32 v73, v73, v45, v46
    v_max_f32 v73, v73, v47
    v_mov_b32 v74, v73
    s_nop 1
    v_permlane32_swap_b32 v73, v74
    s_nop 1
    v_max3_f32 v73, v73, v74, v72
    v_sub_f32 v74, v72, v73
    v_exp_f32 v74, v74
    v_mov_b32 v72, v73
    v_sub_f32 v32, v32, v73
    v_sub_f32 v33, v33, v73
    v_sub_f32 v34, v34, v73
    v_sub_f32 v35, v35, v73
    v_sub_f32 v36, v36, v73
    v_sub_f32 v37, v37, v73
    v_sub_f32 v38, v38, v73
    v_sub_f32 v39, v39, v73
    v_sub_f32 v40, v40, v73
    v_sub_f32 v41, v41, v73
    v_sub_f32 v42, v42, v73
    v_sub_f32 v43, v43, v73
    v_sub_f32 v44, v44, v73
    v_sub_f32 v45, v45, v73
    v_sub_f32 v46, v46, v73
    v_sub_f32 v47, v47, v73
    v_exp_f32 v32, v32
    v_exp_f32 v33, v33
    v_exp_f32 v34, v34
    v_exp_f32 v35, v35
    v_exp_f32 v36, v36
    v_exp_f32 v37, v37
    v_exp_f32 v38, v38
    v_exp_f32 v39, v39
    v_exp_f32 v40, v40
    v_exp_f32 v41, v41
    v_exp_f32 v42, v42
    v_exp_f32 v43, v43
    v_exp_f32 v44, v44
    v_exp_f32 v45, v45
    v_exp_f32 v46, v46
    v_exp_f32 v47, v47
    v_mul_f32 v16, v16, v74
    v_mul_f32 v17, v17, v74
    v_mul_f32 v18, v18, v74
    v_mul_f32 v19, v19, v74
    v_mul_f32 v20, v20, v74
    v_mul_f32 v21, v21, v74
    v_mul_f32 v22, v22, v74
    v_mul_f32 v23, v23, v74
    v_mul_f32 v24, v24, v74
    v_mul_f32 v25, v25, v74
    v_mul_f32 v26, v26, v74
    v_mul_f32 v27, v27, v74
    v_mul_f32 v28, v28, v74
    v_mul_f32 v29, v29, v74
    v_mul_f32 v30, v30, v74
    v_mul_f32 v31, v31, v74
    v_cvt_pk_bf16_f32 v64, v32, v33
    v_cvt_pk_bf16_f32 v65, v34, v35
    v_cvt_pk_bf16_f32 v66, v36, v37
    v_cvt_pk_bf16_f32 v67, v38, v39
    v_cvt_pk_bf16_f32 v68, v40, v41
    v_cvt_pk_bf16_f32 v69, v42, v43
    v_cvt_pk_bf16_f32 v70, v44, v45
    v_cvt_pk_bf16_f32 v71, v46, v47
    s_waitcnt lgkmcnt(0)
    s_nop 1
    v_mfma_f32_32x32x16_bf16 v[16:31], v[56:59], v[64:67], v[16:31]
    v_mfma_f32_32x32x16_bf16 v[16:31], v[60:63], v[68:71], v[16:31]
    s_nop 15
    ds_read_b128 v[48:51], v4 offset:4096
    ds_read_b128 v[52:55], v4 offset:5120
    ds_read_b128 v[56:59], v4 offset:12288
    ds_read_b128 v[60:63], v4 offset:13312
    s_waitcnt lgkmcnt(2)
    v_mfma_f32_32x32x16_bf16 v[32:47], v[48:51], v[8:11], 0
    v_mfma_f32_32x32x16_bf16 v[32:47], v[52:55], v[12:15], v[32:47]
    s_nop 15
    v_max3_f32 v73, v32, v33, v34
    v_max3_f32 v73, v73, v35, v36
    v_max3_f32 v73, v73, v37, v38
    v_max3_f32 v73, v73, v39, v40
    v_max3_f32 v73, v73, v41, v42
    v_max3_f32 v73, v73, v43, v44
    v_max3_f32 v73, v73, v45, v46
    v_max_f32 v73, v73, v47
    v_mov_b32 v74, v73
    s_nop 1
    v_permlane32_swap_b32 v73, v74
    s_nop 1
    v_max3_f32 v73, v73, v74, v72
    v_sub_f32 v74, v72, v73
    v_exp_f32 v74, v74
    v_mov_b32 v72, v73
    v_sub_f32 v32, v32, v73
    v_sub_f32 v33, v33, v73
    v_sub_f32 v34, v34, v73
    v_sub_f32 v35, v35, v73
    v_sub_f32 v36, v36, v73
    v_sub_f32 v37, v37, v73
    v_sub_f32 v38, v38, v73
    v_sub_f32 v39, v39, v73
    v_sub_f32 v40, v40, v73
    v_sub_f32 v41, v41, v73
    v_sub_f32 v42, v42, v73
    v_sub_f32 v43, v43, v73
    v_sub_f32 v44, v44, v73
    v_sub_f32 v45, v45, v73
    v_sub_f32 v46, v46, v73
    v_sub_f32 v47, v47, v73
    v_exp_f32 v32, v32
    v_exp_f32 v33, v33
    v_exp_f32 v34, v34
    v_exp_f32 v35, v35
    v_exp_f32 v36, v36
    v_exp_f32 v37, v37
    v_exp_f32 v38, v38
    v_exp_f32 v39, v39
    v_exp_f32 v40, v40
    v_exp_f32 v41, v41
    v_exp_f32 v42, v42
    v_exp_f32 v43, v43
    v_exp_f32 v44, v44
    v_exp_f32 v45, v45
    v_exp_f32 v46, v46
    v_exp_f32 v47, v47
    v_mul_f32 v16, v16, v74
    v_mul_f32 v17, v17, v74
    v_mul_f32 v18, v18, v74
    v_mul_f32 v19, v19, v74
    v_mul_f32 v20, v20, v74
    v_mul_f32 v21, v21, v74
    v_mul_f32 v22, v22, v74
    v_mul_f32 v23, v23, v74
    v_mul_f32 v24, v24, v74
    v_mul_f32 v25, v25, v74
    v_mul_f32 v26, v26, v74
    v_mul_f32 v27, v27, v74
    v_mul_f32 v28, v28, v74
    v_mul_f32 v29, v29, v74
    v_mul_f32 v30, v30, v74
    v_mul_f32 v31, v31, v74
    v_cvt_pk_bf16_f32 v64, v32, v33
    v_cvt_pk_bf16_f32 v65, v34, v35
    v_cvt_pk_bf16_f32 v66, v36, v37
    v_cvt_pk_bf16_f32 v67, v38, v39
    v_cvt_pk_bf16_f32 v68, v40, v41
    v_cvt_pk_bf16_f32 v69, v42, v43
    v_cvt_pk_bf16_f32 v70, v44, v45
    v_cvt_pk_bf16_f32 v71, v46, v47
    s_waitcnt lgkmcnt(0)
    s_nop 1
    v_mfma_f32_32x32x16_bf16 v[16:31], v[56:59], v[64:67], v[16:31]
    v_mfma_f32_32x32x16_bf16 v[16:31], v[60:63], v[68:71], v[16:31]
    s_nop 15
    ds_read_b128 v[48:51], v4 offset:6144
    ds_read_b128 v[52:55], v4 offset:7168
    ds_read_b128 v[56:59], v4 offset:14336
    ds_read_b128 v[60:63], v4 offset:15360
    s_waitcnt lgkmcnt(2)
    v_mfma_f32_32x32x16_bf16 v[32:47], v[48:51], v[8:11], 0
    v_mfma_f32_32x32x16_bf16 v[32:47], v[52:55], v[12:15], v[32:47]
    s_nop 15
    v_max3_f32 v73, v32, v33, v34
    v_max3_f32 v73, v73, v35, v36
    v_max3_f32 v73, v73, v37, v38
    v_max3_f32 v73, v73, v39, v40
    v_max3_f32 v73, v73, v41, v42
    v_max3_f32 v73, v73, v43, v44
    v_max3_f32 v73, v73, v45, v46
    v_max_f32 v73, v73, v47
    v_mov_b32 v74, v73
    s_nop 1
    v_permlane32_swap_b32 v73, v74
    s_nop 1
    v_max3_f32 v73, v73, v74, v72
    v_sub_f32 v74, v72, v73
    v_exp_f32 v74, v74
    v_mov_b32 v72, v73
    v_sub_f32 v32, v32, v73
    v_sub_f32 v33, v33, v73
    v_sub_f32 v34, v34, v73
    v_sub_f32 v35, v35, v73
    v_sub_f32 v36, v36, v73
    v_sub_f32 v37, v37, v73
    v_sub_f32 v38, v38, v73
    v_sub_f32 v39, v39, v73
    v_sub_f32 v40, v40, v73
    v_sub_f32 v41, v41, v73
    v_sub_f32 v42, v42, v73
    v_sub_f32 v43, v43, v73
    v_sub_f32 v44, v44, v73
    v_sub_f32 v45, v45, v73
    v_sub_f32 v46, v46, v73
    v_sub_f32 v47, v47, v73
    v_exp_f32 v32, v32
    v_exp_f32 v33, v33
    v_exp_f32 v34, v34
    v_exp_f32 v35, v35
    v_exp_f32 v36, v36
    v_exp_f32 v37, v37
    v_exp_f32 v38, v38
    v_exp_f32 v39, v39
    v_exp_f32 v40, v40
    v_exp_f32 v41, v41
    v_exp_f32 v42, v42
    v_exp_f32 v43, v43
    v_exp_f32 v44, v44
    v_exp_f32 v45, v45
    v_exp_f32 v46, v46
    v_exp_f32 v47, v47
    v_mul_f32 v16, v16, v74
    v_mul_f32 v17, v17, v74
    v_mul_f32 v18, v18, v74
    v_mul_f32 v19, v19, v74
    v_mul_f32 v20, v20, v74
    v_mul_f32 v21, v21, v74
    v_mul_f32 v22, v22, v74
    v_mul_f32 v23, v23, v74
    v_mul_f32 v24, v24, v74
    v_mul_f32 v25, v25, v74
    v_mul_f32 v26, v26, v74
    v_mul_f32 v27, v27, v74
    v_mul_f32 v28, v28, v74
    v_mul_f32 v29, v29, v74
    v_mul_f32 v30, v30, v74
    v_mul_f32 v31, v31, v74
    v_cvt_pk_bf16_f32 v64, v32, v33
    v_cvt_pk_bf16_f32 v65, v34, v35
    v_cvt_pk_bf16_f32 v66, v36, v37
    v_cvt_pk_bf16_f32 v67, v38, v39
    v_cvt_pk_bf16_f32 v68, v40, v41
    v_cvt_pk_bf16_f32 v69, v42, v43
    v_cvt_pk_bf16_f32 v70, v44, v45
    v_cvt_pk_bf16_f32 v71, v46, v47
    s_waitcnt lgkmcnt(0)
    s_nop 1
    v_mfma_f32_32x32x16_bf16 v[16:31], v[56:59], v[64:67], v[16:31]
    v_mfma_f32_32x32x16_bf16 v[16:31], v[60:63], v[68:71], v[16:31]
    s_nop 15
    s_add_u32 s67, s67, 16384
    s_and_b32 s67, s67, 0xffff
    s_add_u32 s66, s66, 1
    s_cmp_lt_u32 s66, 16
    s_cbranch_scc1 attn_kernel_loop
    v_mov_b32 v6, v28
    v_mov_b32 v7, v28
    s_nop 1
    v_permlane32_swap_b32 v6, v7
attn_kernel_epi:
    s_nop 1
    v_rcp_f32 v7, v7
    s_nop 0
    v_mul_f32 v16, v16, v7
    v_mul_f32 v17, v17, v7
    v_mul_f32 v18, v18, v7
    v_mul_f32 v19, v19, v7
    v_mul_f32 v20, v20, v7
    v_mul_f32 v21, v21, v7
    v_mul_f32 v22, v22, v7
    v_mul_f32 v23, v23, v7
    v_mul_f32 v24, v24, v7
    v_mul_f32 v25, v25, v7
    v_mul_f32 v26, v26, v7
    v_mul_f32 v27, v27, v7
    v_mul_f32 v28, v28, v7
    v_mul_f32 v29, v29, v7
    v_mul_f32 v30, v30, v7
    v_mul_f32 v31, v31, v7
    v_cvt_pk_bf16_f32 v64, v16, v17
    v_cvt_pk_bf16_f32 v65, v18, v19
    v_cvt_pk_bf16_f32 v66, v20, v21
    v_cvt_pk_bf16_f32 v67, v22, v23
    v_cvt_pk_bf16_f32 v68, v24, v25
    v_cvt_pk_bf16_f32 v69, v26, v27
    v_cvt_pk_bf16_f32 v70, v28, v29
    v_cvt_pk_bf16_f32 v71, v30, v31
    s_lshl_b32 s60, s60, 5
    s_lshl_b32 s61, s41, 1
    s_add_u32 s60, s60, s61
    s_lshl_b32 s60, s60, 10
    buffer_store_dwordx4 v[64:67], v3, s[56:59], s60 offen sc1
    buffer_store_dwordx4 v[68:71], v3, s[56:59], s60 offen offset:1024 sc1
attn_kernel_end:
    s_endpgm
.globl wo_kernel
.p2align 8
.type wo_kernel,@function
wo_kernel:
    s_cmp_ge_u32 s2, 224
    s_cbranch_scc1 wo_kernel_end
    s_load_dwordx16 s[16:31], s[0:1], 0
    s_load_dwordx4 s[32:35], s[0:1], 64
    s_load_dwordx2 s[36:37], s[0:1], 80
    v_lshrrev_b32 v1, 6, v0
    v_and_b32 v2, 63, v0
    v_readfirstlane_b32 s40, v1
    s_and_b32 s41, s2, 31
    s_lshr_b32 s42, s2, 5
    v_lshlrev_b32 v3, 4, v2
    s_waitcnt lgkmcnt(0)
    s_add_u32 s44, s36, 0xaf0000
    s_addc_u32 s45, s37, 0
    s_mov_b32 s46, 0x200000
    s_mov_b32 s47, 0x20000
    s_add_u32 s48, s36, 0x160000
    s_addc_u32 s49, s37, 0
    s_mov_b32 s50, 0x70000
    s_mov_b32 s51, 0x20000
    s_mov_b32 s52, s16
    s_mov_b32 s53, s17
    s_mov_b32 s54, 0x1c0000
    s_mov_b32 s55, 0x20000
    s_add_u32 s56, s36, 0xe00
    s_addc_u32 s57, s37, 0
    s_mov_b32 s58, 0x700
    s_mov_b32 s59, 0x20000
    s_add_u32 s60, s36, 0xcf0000
    s_addc_u32 s61, s37, 0
    s_mov_b32 s62, 0x1c0000
    s_mov_b32 s63, 0x20000
    s_mul_i32 s64, s40, 4096
    s_mul_i32 s65, s41, 65536
    s_add_u32 s65, s65, s64
    s_add_u32 s66, s65, 32768
    s_mul_i32 s67, s42, 65536
    s_add_u32 s67, s67, s64
    s_add_u32 s68, s67, 32768
    buffer_load_dwordx4 v[80:83], v3, s[44:47], s65 offen offset:0
    buffer_load_dwordx4 v[84:87], v3, s[44:47], s66 offen offset:0
    buffer_load_dwordx4 v[88:91], v3, s[48:51], s67 offen offset:0
    buffer_load_dwordx4 v[92:95], v3, s[48:51], s68 offen offset:0
    buffer_load_dwordx4 v[96:99], v3, s[44:47], s65 offen offset:1024
    buffer_load_dwordx4 v[100:103], v3, s[44:47], s66 offen offset:1024
    buffer_load_dwordx4 v[104:107], v3, s[48:51], s67 offen offset:1024
    buffer_load_dwordx4 v[108:111], v3, s[48:51], s68 offen offset:1024
    buffer_load_dwordx4 v[112:115], v3, s[44:47], s65 offen offset:2048
    buffer_load_dwordx4 v[116:119], v3, s[44:47], s66 offen offset:2048
    buffer_load_dwordx4 v[120:123], v3, s[48:51], s67 offen offset:2048
    buffer_load_dwordx4 v[124:127], v3, s[48:51], s68 offen offset:2048
    buffer_load_dwordx4 v[128:131], v3, s[44:47], s65 offen offset:3072
    buffer_load_dwordx4 v[132:135], v3, s[44:47], s66 offen offset:3072
    buffer_load_dwordx4 v[136:139], v3, s[48:51], s67 offen offset:3072
    buffer_load_dwordx4 v[140:143], v3, s[48:51], s68 offen offset:3072
    s_add_u32 s65, s65, 4096
    s_add_u32 s66, s66, 4096
    s_add_u32 s67, s67, 4096
    s_add_u32 s68, s68, 4096
    s_waitcnt vmcnt(12)
    v_mfma_f32_32x32x16_bf16 v[8:23], v[88:91], v[80:83], 0
    v_mfma_f32_32x32x16_bf16 v[24:39], v[92:95], v[80:83], 0
    v_mfma_f32_32x32x16_bf16 v[40:55], v[88:91], v[84:87], 0
    v_mfma_f32_32x32x16_bf16 v[56:71], v[92:95], v[84:87], 0
    s_waitcnt vmcnt(8)
    v_mfma_f32_32x32x16_bf16 v[8:23], v[104:107], v[96:99], v[8:23]
    v_mfma_f32_32x32x16_bf16 v[24:39], v[108:111], v[96:99], v[24:39]
    v_mfma_f32_32x32x16_bf16 v[40:55], v[104:107], v[100:103], v[40:55]
    v_mfma_f32_32x32x16_bf16 v[56:71], v[108:111], v[100:103], v[56:71]
    s_waitcnt vmcnt(4)
    v_mfma_f32_32x32x16_bf16 v[8:23], v[120:123], v[112:115], v[8:23]
    v_mfma_f32_32x32x16_bf16 v[24:39], v[124:127], v[112:115], v[24:39]
    v_mfma_f32_32x32x16_bf16 v[40:55], v[120:123], v[116:119], v[40:55]
    v_mfma_f32_32x32x16_bf16 v[56:71], v[124:127], v[116:119], v[56:71]
    s_waitcnt vmcnt(0)
    v_mfma_f32_32x32x16_bf16 v[8:23], v[136:139], v[128:131], v[8:23]
    v_mfma_f32_32x32x16_bf16 v[24:39], v[140:143], v[128:131], v[24:39]
    v_mfma_f32_32x32x16_bf16 v[40:55], v[136:139], v[132:135], v[40:55]
    v_mfma_f32_32x32x16_bf16 v[56:71], v[140:143], v[132:135], v[56:71]
    s_nop 15
    v_and_b32 v4, 31, v2
    v_mul_u32_u24 v4, 272, v4
    v_lshrrev_b32 v5, 5, v2
    v_lshl_add_u32 v4, v5, 4, v4
    s_mul_i32 s69, s40, 17408
    v_add_u32 v4, s69, v4
    ds_write_b128 v4, v[8:11] offset:0
    ds_write_b128 v4, v[12:15] offset:32
    ds_write_b128 v4, v[16:19] offset:64
    ds_write_b128 v4, v[20:23] offset:96
    ds_write_b128 v4, v[24:27] offset:128
    ds_write_b128 v4, v[28:31] offset:160
    ds_write_b128 v4, v[32:35] offset:192
    ds_write_b128 v4, v[36:39] offset:224
    ds_write_b128 v4, v[40:43] offset:8704
    ds_write_b128 v4, v[44:47] offset:8736
    ds_write_b128 v4, v[48:51] offset:8768
    ds_write_b128 v4, v[52:55] offset:8800
    ds_write_b128 v4, v[56:59] offset:8832
    ds_write_b128 v4, v[60:63] offset:8864
    ds_write_b128 v4, v[64:67] offset:8896
    ds_write_b128 v4, v[68:71] offset:8928
    v_lshrrev_b32 v5, 3, v0
    v_and_b32 v6, 7, v0
    s_lshl_b32 s69, s41, 6
    v_add_u32 v7, s69, v5
    v_mul_u32_u24 v7, 896, v7
    v_lshl_add_u32 v7, v6, 4, v7
    s_lshl_b32 s70, s42, 7
    buffer_load_dwordx4 v[72:75], v7, s[52:55], s70 offen
    v_lshlrev_b32 v76, 5, v6
    s_lshl_b32 s71, s42, 8
    buffer_load_dwordx4 v[80:83], v76, s[56:59], s71 offen
    buffer_load_dwordx4 v[84:87], v76, s[56:59], s71 offen offset:16
    v_mul_u32_u24 v4, 272, v5
    v_lshl_add_u32 v4, v6, 5, v4
    s_waitcnt lgkmcnt(0)
    s_barrier
    ds_read_b128 v[88:91], v4 offset:0
    ds_read_b128 v[92:95], v4 offset:16
    ds_read_b128 v[96:99], v4 offset:17408
    ds_read_b128 v[100:103], v4 offset:17424
    ds_read_b128 v[104:107], v4 offset:34816
    ds_read_b128 v[108:111], v4 offset:34832
    ds_read_b128 v[112:115], v4 offset:52224
    ds_read_b128 v[116:119], v4 offset:52240
    v_add_u32 v4, 69632, v4
    ds_read_b128 v[120:123], v4 offset:0
    ds_read_b128 v[124:127], v4 offset:16
    ds_read_b128 v[128:131], v4 offset:17408
    ds_read_b128 v[132:135], v4 offset:17424
    ds_read_b128 v[136:139], v4 offset:34816
    ds_read_b128 v[140:143], v4 offset:34832
    ds_read_b128 v[144:147], v4 offset:52224
    ds_read_b128 v[148:151], v4 offset:52240
    s_waitcnt lgkmcnt(0)
    v_add_f32 v88, v88, v96
    v_add_f32 v89, v89, v97
    v_add_f32 v90, v90, v98
    v_add_f32 v91, v91, v99
    v_add_f32 v92, v92, v100
    v_add_f32 v93, v93, v101
    v_add_f32 v94, v94, v102
    v_add_f32 v95, v95, v103
    v_add_f32 v88, v88, v104
    v_add_f32 v89, v89, v105
    v_add_f32 v90, v90, v106
    v_add_f32 v91, v91, v107
    v_add_f32 v92, v92, v108
    v_add_f32 v93, v93, v109
    v_add_f32 v94, v94, v110
    v_add_f32 v95, v95, v111
    v_add_f32 v88, v88, v112
    v_add_f32 v89, v89, v113
    v_add_f32 v90, v90, v114
    v_add_f32 v91, v91, v115
    v_add_f32 v92, v92, v116
    v_add_f32 v93, v93, v117
    v_add_f32 v94, v94, v118
    v_add_f32 v95, v95, v119
    v_add_f32 v88, v88, v120
    v_add_f32 v89, v89, v121
    v_add_f32 v90, v90, v122
    v_add_f32 v91, v91, v123
    v_add_f32 v92, v92, v124
    v_add_f32 v93, v93, v125
    v_add_f32 v94, v94, v126
    v_add_f32 v95, v95, v127
    v_add_f32 v88, v88, v128
    v_add_f32 v89, v89, v129
    v_add_f32 v90, v90, v130
    v_add_f32 v91, v91, v131
    v_add_f32 v92, v92, v132
    v_add_f32 v93, v93, v133
    v_add_f32 v94, v94, v134
    v_add_f32 v95, v95, v135
    v_add_f32 v88, v88, v136
    v_add_f32 v89, v89, v137
    v_add_f32 v90, v90, v138
    v_add_f32 v91, v91, v139
    v_add_f32 v92, v92, v140
    v_add_f32 v93, v93, v141
    v_add_f32 v94, v94, v142
    v_add_f32 v95, v95, v143
    v_add_f32 v88, v88, v144
    v_add_f32 v89, v89, v145
    v_add_f32 v90, v90, v146
    v_add_f32 v91, v91, v147
    v_add_f32 v92, v92, v148
    v_add_f32 v93, v93, v149
    v_add_f32 v94, v94, v150
    v_add_f32 v95, v95, v151
    s_waitcnt vmcnt(0)
    v_lshlrev_b32 v100, 16, v72
    v_and_b32 v101, 0xffff0000, v72
    v_lshlrev_b32 v102, 16, v73
    v_and_b32 v103, 0xffff0000, v73
    v_lshlrev_b32 v104, 16, v74
    v_and_b32 v105, 0xffff0000, v74
    v_lshlrev_b32 v106, 16, v75
    v_and_b32 v107, 0xffff0000, v75
    v_fmac_f32 v100, v88, v80
    v_fmac_f32 v101, v89, v81
    v_fmac_f32 v102, v90, v82
    v_fmac_f32 v103, v91, v83
    v_fmac_f32 v104, v92, v84
    v_fmac_f32 v105, v93, v85
    v_fmac_f32 v106, v94, v86
    v_fmac_f32 v107, v95, v87
    v_cvt_pk_bf16_f32 v108, v100, v101
    v_cvt_pk_bf16_f32 v109, v102, v103
    v_cvt_pk_bf16_f32 v110, v104, v105
    v_cvt_pk_bf16_f32 v111, v106, v107
    buffer_store_dwordx4 v[108:111], v7, s[60:63], s70 offen sc1
wo_kernel_end:
    s_endpgm
.globl mlp1_kernel
.p2align 8
.type mlp1_kernel,@function
mlp1_kernel:
    s_cmp_ge_u32 s2, 256
    s_cbranch_scc1 mlp1_kernel_end
    s_load_dwordx16 s[16:31], s[0:1], 0
    s_load_dwordx4 s[32:35], s[0:1], 64
    s_load_dwordx2 s[36:37], s[0:1], 80
    v_lshrrev_b32 v1, 6, v0
    v_and_b32 v2, 63, v0
    v_readfirstlane_b32 s40, v1
    s_lshr_b32 s43, s2, 3
    s_bfe_u32 s41, s2, 0x20001
    s_lshl_b32 s41, s41, 3
    s_and_b32 s42, s43, 7
    s_add_u32 s41, s41, s42
    s_and_b32 s42, s2, 1
    s_lshl_b32 s42, s42, 2
    s_lshr_b32 s43, s43, 3
    s_add_u32 s42, s42, s43
    v_and_b32 v3, 7, v2
    v_lshrrev_b32 v4, 3, v2
    s_waitcnt lgkmcnt(0)
    s_add_u32 s44, s36, 0xcf0000
    s_addc_u32 s45, s37, 0
    s_mov_b32 s46, 0x1c0000
    s_mov_b32 s47, 0x20000
    s_add_u32 s48, s36, 0x1500
    s_addc_u32 s49, s37, 0
    s_mov_b32 s50, 0xe00
    s_mov_b32 s51, 0x20000
    s_add_u32 s52, s36, 0x1d0000
    s_addc_u32 s53, s37, 0
    s_mov_b32 s54, 0x188000
    s_mov_b32 s55, 0x20000
    s_lshl_b32 s60, s41, 6
    s_lshl_b32 s61, s40, 3
    s_add_u32 s60, s60, s61
    v_add_u32 v5, s60, v3
    v_mul_u32_u24 v5, 896, v5
    v_lshl_add_u32 v5, v4, 4, v5
    buffer_load_dwordx4 v[8:11], v5, s[44:47], 0 offen offset:0
    buffer_load_dwordx4 v[12:15], v5, s[44:47], 0 offen offset:128
    buffer_load_dwordx4 v[16:19], v5, s[44:47], 0 offen offset:256
    buffer_load_dwordx4 v[20:23], v5, s[44:47], 0 offen offset:384
    buffer_load_dwordx4 v[24:27], v5, s[44:47], 0 offen offset:512
    buffer_load_dwordx4 v[28:31], v5, s[44:47], 0 offen offset:640
    buffer_load_dwordx4 v[32:35], v5, s[44:47], 0 offen offset:768
    v_lshlrev_b32 v6, 4, v0
    buffer_load_dwordx4 v[36:39], v6, s[48:51], 0 offen
    v_lshlrev_b32 v7, 4, v2
    s_mul_i32 s62, s42, 7
    s_add_u32 s62, s62, s40
    s_mul_i32 s63, s62, 28672
    s_lshr_b32 s60, s40, 2
    s_mul_i32 s60, s60, 28672
    s_and_b32 s61, s40, 3
    s_lshl_b32 s61, s61, 7
    s_add_u32 s60, s60, s61
    s_barrier
    s_cmp_ge_u32 s40, 7
    s_cbranch_scc1 mlp1_kernel_now
    buffer_load_dwordx4 v[128:131], v7, s[52:55], s63 offen offset:0
    buffer_load_dwordx4 v[132:135], v7, s[52:55], s63 offen offset:1024
    buffer_load_dwordx4 v[136:139], v7, s[52:55], s63 offen offset:2048
    buffer_load_dwordx4 v[140:143], v7, s[52:55], s63 offen offset:3072
    s_add_u32 s63, s63, 4096
    buffer_load_dwordx4 v[144:147], v7, s[52:55], s63 offen offset:0
    buffer_load_dwordx4 v[148:151], v7, s[52:55], s63 offen offset:1024
    buffer_load_dwordx4 v[152:155], v7, s[52:55], s63 offen offset:2048
    buffer_load_dwordx4 v[156:159], v7, s[52:55], s63 offen offset:3072
    s_add_u32 s63, s63, 4096
    s_waitcnt vmcnt(8)
    v_add_u32 v6, 57344, v6
    ds_write_b128 v6, v[36:39]
    v_lshlrev_b32 v40, 16, v8
    v_and_b32 v41, 0xffff0000, v8
    v_lshlrev_b32 v42, 16, v9
    v_and_b32 v43, 0xffff0000, v9
    v_lshlrev_b32 v44, 16, v10
    v_and_b32 v45, 0xffff0000, v10
    v_lshlrev_b32 v46, 16, v11
    v_and_b32 v47, 0xffff0000, v11
    v_lshlrev_b32 v48, 16, v12
    v_and_b32 v49, 0xffff0000, v12
    v_lshlrev_b32 v50, 16, v13
    v_and_b32 v51, 0xffff0000, v13
    v_lshlrev_b32 v52, 16, v14
    v_and_b32 v53, 0xffff0000, v14
    v_lshlrev_b32 v54, 16, v15
    v_and_b32 v55, 0xffff0000, v15
    buffer_load_dwordx4 v[160:163], v7, s[52:55], s63 offen offset:0
    v_lshlrev_b32 v56, 16, v16
    v_and_b32 v57, 0xffff0000, v16
    v_lshlrev_b32 v58, 16, v17
    v_and_b32 v59, 0xffff0000, v17
    v_lshlrev_b32 v60, 16, v18
    v_and_b32 v61, 0xffff0000, v18
    v_lshlrev_b32 v62, 16, v19
    v_and_b32 v63, 0xffff0000, v19
    v_lshlrev_b32 v64, 16, v20
    v_and_b32 v65, 0xffff0000, v20
    v_lshlrev_b32 v66, 16, v21
    v_and_b32 v67, 0xffff0000, v21
    v_lshlrev_b32 v68, 16, v22
    v_and_b32 v69, 0xffff0000, v22
    v_lshlrev_b32 v70, 16, v23
    v_and_b32 v71, 0xffff0000, v23
    v_lshlrev_b32 v72, 16, v24
    v_and_b32 v73, 0xffff0000, v24
    buffer_load_dwordx4 v[164:167], v7, s[52:55], s63 offen offset:1024
    v_lshlrev_b32 v74, 16, v25
    v_and_b32 v75, 0xffff0000, v25
    v_lshlrev_b32 v76, 16, v26
    v_and_b32 v77, 0xffff0000, v26
    v_lshlrev_b32 v78, 16, v27
    v_and_b32 v79, 0xffff0000, v27
    v_lshlrev_b32 v80, 16, v28
    v_and_b32 v81, 0xffff0000, v28
    v_lshlrev_b32 v82, 16, v29
    v_and_b32 v83, 0xffff0000, v29
    v_lshlrev_b32 v84, 16, v30
    v_and_b32 v85, 0xffff0000, v30
    v_lshlrev_b32 v86, 16, v31
    v_and_b32 v87, 0xffff0000, v31
    v_lshlrev_b32 v88, 16, v32
    v_and_b32 v89, 0xffff0000, v32
    v_lshlrev_b32 v90, 16, v33
    v_and_b32 v91, 0xffff0000, v33
    buffer_load_dwordx4 v[168:171], v7, s[52:55], s63 offen offset:2048
    v_lshlrev_b32 v92, 16, v34
    v_and_b32 v93, 0xffff0000, v34
    v_lshlrev_b32 v94, 16, v35
    v_and_b32 v95, 0xffff0000, v35
    v_pk_add_f32 v[96:97], v[40:41], v[42:43]
    v_pk_add_f32 v[98:99], v[44:45], v[46:47]
    v_pk_add_f32 v[96:97], v[96:97], v[48:49]
    v_pk_add_f32 v[98:99], v[98:99], v[50:51]
    v_pk_add_f32 v[96:97], v[96:97], v[52:53]
    v_pk_add_f32 v[98:99], v[98:99], v[54:55]
    v_pk_add_f32 v[96:97], v[96:97], v[56:57]
    v_pk_add_f32 v[98:99], v[98:99], v[58:59]
    v_pk_add_f32 v[96:97], v[96:97], v[60:61]
    v_pk_add_f32 v[98:99], v[98:99], v[62:63]
    v_pk_add_f32 v[96:97], v[96:97], v[64:65]
    v_pk_add_f32 v[98:99], v[98:99], v[66:67]
    v_pk_add_f32 v[96:97], v[96:97], v[68:69]
    v_pk_add_f32 v[98:99], v[98:99], v[70:71]
    buffer_load_dwordx4 v[172:175], v7, s[52:55], s63 offen offset:3072
    s_add_u32 s63, s63, 4096
    v_pk_add_f32 v[96:97], v[96:97], v[72:73]
    v_pk_add_f32 v[98:99], v[98:99], v[74:75]
    v_pk_add_f32 v[96:97], v[96:97], v[76:77]
    v_pk_add_f32 v[98:99], v[98:99], v[78:79]
    v_pk_add_f32 v[96:97], v[96:97], v[80:81]
    v_pk_add_f32 v[98:99], v[98:99], v[82:83]
    v_pk_add_f32 v[96:97], v[96:97], v[84:85]
    v_pk_add_f32 v[98:99], v[98:99], v[86:87]
    v_pk_add_f32 v[96:97], v[96:97], v[88:89]
    v_pk_add_f32 v[98:99], v[98:99], v[90:91]
    v_pk_add_f32 v[96:97], v[96:97], v[92:93]
    v_pk_add_f32 v[98:99], v[98:99], v[94:95]
    v_pk_add_f32 v[96:97], v[96:97], v[98:99]
    v_add_f32 v96, v96, v97
    s_nop 1
    v_add_f32_dpp v100, v96, v96 row_ror:8 row_mask:0xf bank_mask:0xf
    v_mov_b32 v101, v100
    s_nop 1
    buffer_load_dwordx4 v[176:179], v7, s[52:55], s63 offen offset:0
    v_permlane16_swap_b32 v100, v101
    s_nop 1
    v_add_f32 v100, v100, v101
    v_mov_b32 v101, v100
    s_nop 1
    v_permlane32_swap_b32 v100, v101
    s_nop 1
    v_add_f32 v96, v100, v101
    v_mul_f32 v96, 0xbb124925, v96
    v_mov_b32 v97, v96
    v_pk_add_f32 v[40:41], v[40:41], v[96:97]
    v_pk_add_f32 v[42:43], v[42:43], v[96:97]
    v_pk_add_f32 v[44:45], v[44:45], v[96:97]
    v_pk_add_f32 v[46:47], v[46:47], v[96:97]
    v_pk_add_f32 v[48:49], v[48:49], v[96:97]
    v_pk_add_f32 v[50:51], v[50:51], v[96:97]
    v_pk_add_f32 v[52:53], v[52:53], v[96:97]
    v_pk_add_f32 v[54:55], v[54:55], v[96:97]
    buffer_load_dwordx4 v[180:183], v7, s[52:55], s63 offen offset:1024
    v_pk_add_f32 v[56:57], v[56:57], v[96:97]
    v_pk_add_f32 v[58:59], v[58:59], v[96:97]
    v_pk_add_f32 v[60:61], v[60:61], v[96:97]
    v_pk_add_f32 v[62:63], v[62:63], v[96:97]
    v_pk_add_f32 v[64:65], v[64:65], v[96:97]
    v_pk_add_f32 v[66:67], v[66:67], v[96:97]
    v_pk_add_f32 v[68:69], v[68:69], v[96:97]
    v_pk_add_f32 v[70:71], v[70:71], v[96:97]
    v_pk_add_f32 v[72:73], v[72:73], v[96:97]
    v_pk_add_f32 v[74:75], v[74:75], v[96:97]
    v_pk_add_f32 v[76:77], v[76:77], v[96:97]
    v_pk_add_f32 v[78:79], v[78:79], v[96:97]
    v_pk_add_f32 v[80:81], v[80:81], v[96:97]
    v_pk_add_f32 v[82:83], v[82:83], v[96:97]
    v_pk_add_f32 v[84:85], v[84:85], v[96:97]
    v_pk_add_f32 v[86:87], v[86:87], v[96:97]
    v_pk_add_f32 v[88:89], v[88:89], v[96:97]
    v_pk_add_f32 v[90:91], v[90:91], v[96:97]
    buffer_load_dwordx4 v[184:187], v7, s[52:55], s63 offen offset:2048
    v_pk_add_f32 v[92:93], v[92:93], v[96:97]
    v_pk_add_f32 v[94:95], v[94:95], v[96:97]
    v_pk_mul_f32 v[98:99], v[40:41], v[40:41]
    v_pk_mul_f32 v[100:101], v[42:43], v[42:43]
    v_pk_fma_f32 v[98:99], v[44:45], v[44:45], v[98:99]
    v_pk_fma_f32 v[100:101], v[46:47], v[46:47], v[100:101]
    v_pk_fma_f32 v[98:99], v[48:49], v[48:49], v[98:99]
    v_pk_fma_f32 v[100:101], v[50:51], v[50:51], v[100:101]
    v_pk_fma_f32 v[98:99], v[52:53], v[52:53], v[98:99]
    v_pk_fma_f32 v[100:101], v[54:55], v[54:55], v[100:101]
    v_pk_fma_f32 v[98:99], v[56:57], v[56:57], v[98:99]
    v_pk_fma_f32 v[100:101], v[58:59], v[58:59], v[100:101]
    v_pk_fma_f32 v[98:99], v[60:61], v[60:61], v[98:99]
    v_pk_fma_f32 v[100:101], v[62:63], v[62:63], v[100:101]
    v_pk_fma_f32 v[98:99], v[64:65], v[64:65], v[98:99]
    v_pk_fma_f32 v[100:101], v[66:67], v[66:67], v[100:101]
    v_pk_fma_f32 v[98:99], v[68:69], v[68:69], v[98:99]
    v_pk_fma_f32 v[100:101], v[70:71], v[70:71], v[100:101]
    buffer_load_dwordx4 v[188:191], v7, s[52:55], s63 offen offset:3072
    s_add_u32 s63, s63, 4096
    v_pk_fma_f32 v[98:99], v[72:73], v[72:73], v[98:99]
    v_pk_fma_f32 v[100:101], v[74:75], v[74:75], v[100:101]
    v_pk_fma_f32 v[98:99], v[76:77], v[76:77], v[98:99]
    v_pk_fma_f32 v[100:101], v[78:79], v[78:79], v[100:101]
    v_pk_fma_f32 v[98:99], v[80:81], v[80:81], v[98:99]
    v_pk_fma_f32 v[100:101], v[82:83], v[82:83], v[100:101]
    v_pk_fma_f32 v[98:99], v[84:85], v[84:85], v[98:99]
    v_pk_fma_f32 v[100:101], v[86:87], v[86:87], v[100:101]
    v_pk_fma_f32 v[98:99], v[88:89], v[88:89], v[98:99]
    v_pk_fma_f32 v[100:101], v[90:91], v[90:91], v[100:101]
    v_pk_fma_f32 v[98:99], v[92:93], v[92:93], v[98:99]
    v_pk_fma_f32 v[100:101], v[94:95], v[94:95], v[100:101]
    v_pk_add_f32 v[98:99], v[98:99], v[100:101]
    v_add_f32 v97, v98, v99
    s_nop 1
    v_add_f32_dpp v100, v97, v97 row_ror:8 row_mask:0xf bank_mask:0xf
    v_mov_b32 v101, v100
    s_nop 1
    buffer_load_dwordx4 v[192:195], v7, s[52:55], s63 offen offset:0
    v_permlane16_swap_b32 v100, v101
    s_nop 1
    v_add_f32 v100, v100, v101
    v_mov_b32 v101, v100
    s_nop 1
    v_permlane32_swap_b32 v100, v101
    s_nop 1
    v_add_f32 v97, v100, v101
    v_mov_b32 v98, 0x3727c5ac
    v_fmac_f32 v98, 0x3b124925, v97
    v_rsq_f32 v98, v98
    v_lshlrev_b32 v5, 5, v4
    v_add_u32 v5, 57344, v5
    v_lshrrev_b32 v6, 1, v4
    v_lshlrev_b32 v6, 10, v6
    v_and_b32 v36, 1, v4
    v_lshl_add_u32 v6, v36, 9, v6
    v_lshl_add_u32 v6, v3, 4, v6
    buffer_load_dwordx4 v[196:199], v7, s[52:55], s63 offen offset:1024
    v_add_u32 v6, s60, v6
    v_mov_b32 v99, v98
    s_waitcnt lgkmcnt(0)
    s_barrier
    ds_read_b128 v[8:11], v5 offset:0
    ds_read_b128 v[12:15], v5 offset:16
    ds_read_b128 v[16:19], v5 offset:1792
    ds_read_b128 v[20:23], v5 offset:1808
    v_pk_mul_f32 v[40:41], v[40:41], v[98:99]
    v_pk_mul_f32 v[42:43], v[42:43], v[98:99]
    v_pk_mul_f32 v[44:45], v[44:45], v[98:99]
    v_pk_mul_f32 v[46:47], v[46:47], v[98:99]
    s_waitcnt lgkmcnt(0)
    ds_read_b128 v[24:27], v5 offset:256
    ds_read_b128 v[28:31], v5 offset:272
    ds_read_b128 v[32:35], v5 offset:2048
    ds_read_b128 v[36:39], v5 offset:2064
    v_pk_fma_f32 v[40:41], v[40:41], v[16:17], v[8:9]
    v_pk_fma_f32 v[42:43], v[42:43], v[18:19], v[10:11]
    v_pk_fma_f32 v[44:45], v[44:45], v[20:21], v[12:13]
    v_pk_fma_f32 v[46:47], v[46:47], v[22:23], v[14:15]
    buffer_load_dwordx4 v[200:203], v7, s[52:55], s63 offen offset:2048
    v_cvt_pk_bf16_f32 v100, v40, v41
    v_cvt_pk_bf16_f32 v101, v42, v43
    v_cvt_pk_bf16_f32 v102, v44, v45
    v_cvt_pk_bf16_f32 v103, v46, v47
    ds_write_b128 v6, v[100:103] offset:0
    v_pk_mul_f32 v[48:49], v[48:49], v[98:99]
    v_pk_mul_f32 v[50:51], v[50:51], v[98:99]
    v_pk_mul_f32 v[52:53], v[52:53], v[98:99]
    v_pk_mul_f32 v[54:55], v[54:55], v[98:99]
    s_waitcnt lgkmcnt(1)
    ds_read_b128 v[8:11], v5 offset:512
    ds_read_b128 v[12:15], v5 offset:528
    ds_read_b128 v[16:19], v5 offset:2304
    ds_read_b128 v[20:23], v5 offset:2320
    v_pk_fma_f32 v[48:49], v[48:49], v[32:33], v[24:25]
    v_pk_fma_f32 v[50:51], v[50:51], v[34:35], v[26:27]
    v_pk_fma_f32 v[52:53], v[52:53], v[36:37], v[28:29]
    v_pk_fma_f32 v[54:55], v[54:55], v[38:39], v[30:31]
    v_cvt_pk_bf16_f32 v104, v48, v49
    buffer_load_dwordx4 v[204:207], v7, s[52:55], s63 offen offset:3072
    s_add_u32 s63, s63, 4096
    v_cvt_pk_bf16_f32 v105, v50, v51
    v_cvt_pk_bf16_f32 v106, v52, v53
    v_cvt_pk_bf16_f32 v107, v54, v55
    ds_write_b128 v6, v[104:107] offset:4096
    v_pk_mul_f32 v[56:57], v[56:57], v[98:99]
    v_pk_mul_f32 v[58:59], v[58:59], v[98:99]
    v_pk_mul_f32 v[60:61], v[60:61], v[98:99]
    v_pk_mul_f32 v[62:63], v[62:63], v[98:99]
    s_waitcnt lgkmcnt(1)
    ds_read_b128 v[24:27], v5 offset:768
    ds_read_b128 v[28:31], v5 offset:784
    ds_read_b128 v[32:35], v5 offset:2560
    ds_read_b128 v[36:39], v5 offset:2576
    v_pk_fma_f32 v[56:57], v[56:57], v[16:17], v[8:9]
    v_pk_fma_f32 v[58:59], v[58:59], v[18:19], v[10:11]
    v_pk_fma_f32 v[60:61], v[60:61], v[20:21], v[12:13]
    v_pk_fma_f32 v[62:63], v[62:63], v[22:23], v[14:15]
    v_cvt_pk_bf16_f32 v100, v56, v57
    v_cvt_pk_bf16_f32 v101, v58, v59
    buffer_load_dwordx4 v[208:211], v7, s[52:55], s63 offen offset:0
    v_cvt_pk_bf16_f32 v102, v60, v61
    v_cvt_pk_bf16_f32 v103, v62, v63
    ds_write_b128 v6, v[100:103] offset:8192
    v_pk_mul_f32 v[64:65], v[64:65], v[98:99]
    v_pk_mul_f32 v[66:67], v[66:67], v[98:99]
    v_pk_mul_f32 v[68:69], v[68:69], v[98:99]
    v_pk_mul_f32 v[70:71], v[70:71], v[98:99]
    s_waitcnt lgkmcnt(1)
    ds_read_b128 v[8:11], v5 offset:1024
    ds_read_b128 v[12:15], v5 offset:1040
    ds_read_b128 v[16:19], v5 offset:2816
    ds_read_b128 v[20:23], v5 offset:2832
    v_pk_fma_f32 v[64:65], v[64:65], v[32:33], v[24:25]
    v_pk_fma_f32 v[66:67], v[66:67], v[34:35], v[26:27]
    v_pk_fma_f32 v[68:69], v[68:69], v[36:37], v[28:29]
    v_pk_fma_f32 v[70:71], v[70:71], v[38:39], v[30:31]
    v_cvt_pk_bf16_f32 v104, v64, v65
    v_cvt_pk_bf16_f32 v105, v66, v67
    v_cvt_pk_bf16_f32 v106, v68, v69
    buffer_load_dwordx4 v[212:215], v7, s[52:55], s63 offen offset:1024
    v_cvt_pk_bf16_f32 v107, v70, v71
    ds_write_b128 v6, v[104:107] offset:12288
    v_pk_mul_f32 v[72:73], v[72:73], v[98:99]
    v_pk_mul_f32 v[74:75], v[74:75], v[98:99]
    v_pk_mul_f32 v[76:77], v[76:77], v[98:99]
    v_pk_mul_f32 v[78:79], v[78:79], v[98:99]
    s_waitcnt lgkmcnt(1)
    ds_read_b128 v[24:27], v5 offset:1280
    ds_read_b128 v[28:31], v5 offset:1296
    ds_read_b128 v[32:35], v5 offset:3072
    ds_read_b128 v[36:39], v5 offset:3088
    v_pk_fma_f32 v[72:73], v[72:73], v[16:17], v[8:9]
    v_pk_fma_f32 v[74:75], v[74:75], v[18:19], v[10:11]
    v_pk_fma_f32 v[76:77], v[76:77], v[20:21], v[12:13]
    v_pk_fma_f32 v[78:79], v[78:79], v[22:23], v[14:15]
    v_cvt_pk_bf16_f32 v100, v72, v73
    v_cvt_pk_bf16_f32 v101, v74, v75
    v_cvt_pk_bf16_f32 v102, v76, v77
    v_cvt_pk_bf16_f32 v103, v78, v79
    buffer_load_dwordx4 v[216:219], v7, s[52:55], s63 offen offset:2048
    ds_write_b128 v6, v[100:103] offset:16384
    v_pk_mul_f32 v[80:81], v[80:81], v[98:99]
    v_pk_mul_f32 v[82:83], v[82:83], v[98:99]
    v_pk_mul_f32 v[84:85], v[84:85], v[98:99]
    v_pk_mul_f32 v[86:87], v[86:87], v[98:99]
    s_waitcnt lgkmcnt(1)
    ds_read_b128 v[8:11], v5 offset:1536
    ds_read_b128 v[12:15], v5 offset:1552
    ds_read_b128 v[16:19], v5 offset:3328
    ds_read_b128 v[20:23], v5 offset:3344
    v_pk_fma_f32 v[80:81], v[80:81], v[32:33], v[24:25]
    v_pk_fma_f32 v[82:83], v[82:83], v[34:35], v[26:27]
    v_pk_fma_f32 v[84:85], v[84:85], v[36:37], v[28:29]
    v_pk_fma_f32 v[86:87], v[86:87], v[38:39], v[30:31]
    v_cvt_pk_bf16_f32 v104, v80, v81
    v_cvt_pk_bf16_f32 v105, v82, v83
    v_cvt_pk_bf16_f32 v106, v84, v85
    v_cvt_pk_bf16_f32 v107, v86, v87
    ds_write_b128 v6, v[104:107] offset:20480
    buffer_load_dwordx4 v[220:223], v7, s[52:55], s63 offen offset:3072
    s_add_u32 s63, s63, 4096
    v_pk_mul_f32 v[88:89], v[88:89], v[98:99]
    v_pk_mul_f32 v[90:91], v[90:91], v[98:99]
    v_pk_mul_f32 v[92:93], v[92:93], v[98:99]
    v_pk_mul_f32 v[94:95], v[94:95], v[98:99]
    s_waitcnt lgkmcnt(0)
    v_pk_fma_f32 v[88:89], v[88:89], v[16:17], v[8:9]
    v_pk_fma_f32 v[90:91], v[90:91], v[18:19], v[10:11]
    v_pk_fma_f32 v[92:93], v[92:93], v[20:21], v[12:13]
    v_pk_fma_f32 v[94:95], v[94:95], v[22:23], v[14:15]
    v_cvt_pk_bf16_f32 v100, v88, v89
    v_cvt_pk_bf16_f32 v101, v90, v91
    v_cvt_pk_bf16_f32 v102, v92, v93
    v_cvt_pk_bf16_f32 v103, v94, v95
    ds_write_b128 v6, v[100:103] offset:24576
    buffer_load_dwordx4 v[224:227], v7, s[52:55], s63 offen offset:0
    buffer_load_dwordx4 v[228:231], v7, s[52:55], s63 offen offset:1024
    buffer_load_dwordx4 v[232:235], v7, s[52:55], s63 offen offset:2048
    buffer_load_dwordx4 v[236:239], v7, s[52:55], s63 offen offset:3072
    s_add_u32 s63, s63, 4096
    s_waitcnt lgkmcnt(0)
    s_barrier
    s_branch mlp1_kernel_gemm
mlp1_kernel_now:
    s_waitcnt vmcnt(0)
    v_add_u32 v6, 57344, v6
    ds_write_b128 v6, v[36:39]
    v_lshlrev_b32 v40, 16, v8
    v_and_b32 v41, 0xffff0000, v8
    v_lshlrev_b32 v42, 16, v9
    v_and_b32 v43, 0xffff0000, v9
    v_lshlrev_b32 v44, 16, v10
    v_and_b32 v45, 0xffff0000, v10
    v_lshlrev_b32 v46, 16, v11
    v_and_b32 v47, 0xffff0000, v11
    v_lshlrev_b32 v48, 16, v12
    v_and_b32 v49, 0xffff0000, v12
    v_lshlrev_b32 v50, 16, v13
    v_and_b32 v51, 0xffff0000, v13
    v_lshlrev_b32 v52, 16, v14
    v_and_b32 v53, 0xffff0000, v14
    v_lshlrev_b32 v54, 16, v15
    v_and_b32 v55, 0xffff0000, v15
    v_lshlrev_b32 v56, 16, v16
    v_and_b32 v57, 0xffff0000, v16
    v_lshlrev_b32 v58, 16, v17
    v_and_b32 v59, 0xffff0000, v17
    v_lshlrev_b32 v60, 16, v18
    v_and_b32 v61, 0xffff0000, v18
    v_lshlrev_b32 v62, 16, v19
    v_and_b32 v63, 0xffff0000, v19
    v_lshlrev_b32 v64, 16, v20
    v_and_b32 v65, 0xffff0000, v20
    v_lshlrev_b32 v66, 16, v21
    v_and_b32 v67, 0xffff0000, v21
    v_lshlrev_b32 v68, 16, v22
    v_and_b32 v69, 0xffff0000, v22
    v_lshlrev_b32 v70, 16, v23
    v_and_b32 v71, 0xffff0000, v23
    v_lshlrev_b32 v72, 16, v24
    v_and_b32 v73, 0xffff0000, v24
    v_lshlrev_b32 v74, 16, v25
    v_and_b32 v75, 0xffff0000, v25
    v_lshlrev_b32 v76, 16, v26
    v_and_b32 v77, 0xffff0000, v26
    v_lshlrev_b32 v78, 16, v27
    v_and_b32 v79, 0xffff0000, v27
    v_lshlrev_b32 v80, 16, v28
    v_and_b32 v81, 0xffff0000, v28
    v_lshlrev_b32 v82, 16, v29
    v_and_b32 v83, 0xffff0000, v29
    v_lshlrev_b32 v84, 16, v30
    v_and_b32 v85, 0xffff0000, v30
    v_lshlrev_b32 v86, 16, v31
    v_and_b32 v87, 0xffff0000, v31
    v_lshlrev_b32 v88, 16, v32
    v_and_b32 v89, 0xffff0000, v32
    v_lshlrev_b32 v90, 16, v33
    v_and_b32 v91, 0xffff0000, v33
    v_lshlrev_b32 v92, 16, v34
    v_and_b32 v93, 0xffff0000, v34
    v_lshlrev_b32 v94, 16, v35
    v_and_b32 v95, 0xffff0000, v35
    v_pk_add_f32 v[96:97], v[40:41], v[42:43]
    v_pk_add_f32 v[98:99], v[44:45], v[46:47]
    v_pk_add_f32 v[96:97], v[96:97], v[48:49]
    v_pk_add_f32 v[98:99], v[98:99], v[50:51]
    v_pk_add_f32 v[96:97], v[96:97], v[52:53]
    v_pk_add_f32 v[98:99], v[98:99], v[54:55]
    v_pk_add_f32 v[96:97], v[96:97], v[56:57]
    v_pk_add_f32 v[98:99], v[98:99], v[58:59]
    v_pk_add_f32 v[96:97], v[96:97], v[60:61]
    v_pk_add_f32 v[98:99], v[98:99], v[62:63]
    v_pk_add_f32 v[96:97], v[96:97], v[64:65]
    v_pk_add_f32 v[98:99], v[98:99], v[66:67]
    v_pk_add_f32 v[96:97], v[96:97], v[68:69]
    v_pk_add_f32 v[98:99], v[98:99], v[70:71]
    v_pk_add_f32 v[96:97], v[96:97], v[72:73]
    v_pk_add_f32 v[98:99], v[98:99], v[74:75]
    v_pk_add_f32 v[96:97], v[96:97], v[76:77]
    v_pk_add_f32 v[98:99], v[98:99], v[78:79]
    v_pk_add_f32 v[96:97], v[96:97], v[80:81]
    v_pk_add_f32 v[98:99], v[98:99], v[82:83]
    v_pk_add_f32 v[96:97], v[96:97], v[84:85]
    v_pk_add_f32 v[98:99], v[98:99], v[86:87]
    v_pk_add_f32 v[96:97], v[96:97], v[88:89]
    v_pk_add_f32 v[98:99], v[98:99], v[90:91]
    v_pk_add_f32 v[96:97], v[96:97], v[92:93]
    v_pk_add_f32 v[98:99], v[98:99], v[94:95]
    v_pk_add_f32 v[96:97], v[96:97], v[98:99]
    v_add_f32 v96, v96, v97
    s_nop 1
    v_add_f32_dpp v100, v96, v96 row_ror:8 row_mask:0xf bank_mask:0xf
    v_mov_b32 v101, v100
    s_nop 1
    v_permlane16_swap_b32 v100, v101
    s_nop 1
    v_add_f32 v100, v100, v101
    v_mov_b32 v101, v100
    s_nop 1
    v_permlane32_swap_b32 v100, v101
    s_nop 1
    v_add_f32 v96, v100, v101
    v_mul_f32 v96, 0xbb124925, v96
    v_mov_b32 v97, v96
    v_pk_add_f32 v[40:41], v[40:41], v[96:97]
    v_pk_add_f32 v[42:43], v[42:43], v[96:97]
    v_pk_add_f32 v[44:45], v[44:45], v[96:97]
    v_pk_add_f32 v[46:47], v[46:47], v[96:97]
    v_pk_add_f32 v[48:49], v[48:49], v[96:97]
    v_pk_add_f32 v[50:51], v[50:51], v[96:97]
    v_pk_add_f32 v[52:53], v[52:53], v[96:97]
    v_pk_add_f32 v[54:55], v[54:55], v[96:97]
    v_pk_add_f32 v[56:57], v[56:57], v[96:97]
    v_pk_add_f32 v[58:59], v[58:59], v[96:97]
    v_pk_add_f32 v[60:61], v[60:61], v[96:97]
    v_pk_add_f32 v[62:63], v[62:63], v[96:97]
    v_pk_add_f32 v[64:65], v[64:65], v[96:97]
    v_pk_add_f32 v[66:67], v[66:67], v[96:97]
    v_pk_add_f32 v[68:69], v[68:69], v[96:97]
    v_pk_add_f32 v[70:71], v[70:71], v[96:97]
    v_pk_add_f32 v[72:73], v[72:73], v[96:97]
    v_pk_add_f32 v[74:75], v[74:75], v[96:97]
    v_pk_add_f32 v[76:77], v[76:77], v[96:97]
    v_pk_add_f32 v[78:79], v[78:79], v[96:97]
    v_pk_add_f32 v[80:81], v[80:81], v[96:97]
    v_pk_add_f32 v[82:83], v[82:83], v[96:97]
    v_pk_add_f32 v[84:85], v[84:85], v[96:97]
    v_pk_add_f32 v[86:87], v[86:87], v[96:97]
    v_pk_add_f32 v[88:89], v[88:89], v[96:97]
    v_pk_add_f32 v[90:91], v[90:91], v[96:97]
    v_pk_add_f32 v[92:93], v[92:93], v[96:97]
    v_pk_add_f32 v[94:95], v[94:95], v[96:97]
    v_pk_mul_f32 v[98:99], v[40:41], v[40:41]
    v_pk_mul_f32 v[100:101], v[42:43], v[42:43]
    v_pk_fma_f32 v[98:99], v[44:45], v[44:45], v[98:99]
    v_pk_fma_f32 v[100:101], v[46:47], v[46:47], v[100:101]
    v_pk_fma_f32 v[98:99], v[48:49], v[48:49], v[98:99]
    v_pk_fma_f32 v[100:101], v[50:51], v[50:51], v[100:101]
    v_pk_fma_f32 v[98:99], v[52:53], v[52:53], v[98:99]
    v_pk_fma_f32 v[100:101], v[54:55], v[54:55], v[100:101]
    v_pk_fma_f32 v[98:99], v[56:57], v[56:57], v[98:99]
    v_pk_fma_f32 v[100:101], v[58:59], v[58:59], v[100:101]
    v_pk_fma_f32 v[98:99], v[60:61], v[60:61], v[98:99]
    v_pk_fma_f32 v[100:101], v[62:63], v[62:63], v[100:101]
    v_pk_fma_f32 v[98:99], v[64:65], v[64:65], v[98:99]
    v_pk_fma_f32 v[100:101], v[66:67], v[66:67], v[100:101]
    v_pk_fma_f32 v[98:99], v[68:69], v[68:69], v[98:99]
    v_pk_fma_f32 v[100:101], v[70:71], v[70:71], v[100:101]
    v_pk_fma_f32 v[98:99], v[72:73], v[72:73], v[98:99]
    v_pk_fma_f32 v[100:101], v[74:75], v[74:75], v[100:101]
    v_pk_fma_f32 v[98:99], v[76:77], v[76:77], v[98:99]
    v_pk_fma_f32 v[100:101], v[78:79], v[78:79], v[100:101]
    v_pk_fma_f32 v[98:99], v[80:81], v[80:81], v[98:99]
    v_pk_fma_f32 v[100:101], v[82:83], v[82:83], v[100:101]
    v_pk_fma_f32 v[98:99], v[84:85], v[84:85], v[98:99]
    v_pk_fma_f32 v[100:101], v[86:87], v[86:87], v[100:101]
    v_pk_fma_f32 v[98:99], v[88:89], v[88:89], v[98:99]
    v_pk_fma_f32 v[100:101], v[90:91], v[90:91], v[100:101]
    v_pk_fma_f32 v[98:99], v[92:93], v[92:93], v[98:99]
    v_pk_fma_f32 v[100:101], v[94:95], v[94:95], v[100:101]
    v_pk_add_f32 v[98:99], v[98:99], v[100:101]
    v_add_f32 v97, v98, v99
    s_nop 1
    v_add_f32_dpp v100, v97, v97 row_ror:8 row_mask:0xf bank_mask:0xf
    v_mov_b32 v101, v100
    s_nop 1
    v_permlane16_swap_b32 v100, v101
    s_nop 1
    v_add_f32 v100, v100, v101
    v_mov_b32 v101, v100
    s_nop 1
    v_permlane32_swap_b32 v100, v101
    s_nop 1
    v_add_f32 v97, v100, v101
    v_mov_b32 v98, 0x3727c5ac
    v_fmac_f32 v98, 0x3b124925, v97
    v_rsq_f32 v98, v98
    v_lshlrev_b32 v5, 5, v4
    v_add_u32 v5, 57344, v5
    v_lshrrev_b32 v6, 1, v4
    v_lshlrev_b32 v6, 10, v6
    v_and_b32 v36, 1, v4
    v_lshl_add_u32 v6, v36, 9, v6
    v_lshl_add_u32 v6, v3, 4, v6
    v_add_u32 v6, s60, v6
    v_mov_b32 v99, v98
    s_waitcnt lgkmcnt(0)
    s_barrier
    ds_read_b128 v[8:11], v5 offset:0
    ds_read_b128 v[12:15], v5 offset:16
    ds_read_b128 v[16:19], v5 offset:1792
    ds_read_b128 v[20:23], v5 offset:1808
    v_pk_mul_f32 v[40:41], v[40:41], v[98:99]
    v_pk_mul_f32 v[42:43], v[42:43], v[98:99]
    v_pk_mul_f32 v[44:45], v[44:45], v[98:99]
    v_pk_mul_f32 v[46:47], v[46:47], v[98:99]
    s_waitcnt lgkmcnt(0)
    ds_read_b128 v[24:27], v5 offset:256
    ds_read_b128 v[28:31], v5 offset:272
    ds_read_b128 v[32:35], v5 offset:2048
    ds_read_b128 v[36:39], v5 offset:2064
    v_pk_fma_f32 v[40:41], v[40:41], v[16:17], v[8:9]
    v_pk_fma_f32 v[42:43], v[42:43], v[18:19], v[10:11]
    v_pk_fma_f32 v[44:45], v[44:45], v[20:21], v[12:13]
    v_pk_fma_f32 v[46:47], v[46:47], v[22:23], v[14:15]
    v_cvt_pk_bf16_f32 v100, v40, v41
    v_cvt_pk_bf16_f32 v101, v42, v43
    v_cvt_pk_bf16_f32 v102, v44, v45
    v_cvt_pk_bf16_f32 v103, v46, v47
    ds_write_b128 v6, v[100:103] offset:0
    v_pk_mul_f32 v[48:49], v[48:49], v[98:99]
    v_pk_mul_f32 v[50:51], v[50:51], v[98:99]
    v_pk_mul_f32 v[52:53], v[52:53], v[98:99]
    v_pk_mul_f32 v[54:55], v[54:55], v[98:99]
    s_waitcnt lgkmcnt(1)
    ds_read_b128 v[8:11], v5 offset:512
    ds_read_b128 v[12:15], v5 offset:528
    ds_read_b128 v[16:19], v5 offset:2304
    ds_read_b128 v[20:23], v5 offset:2320
    v_pk_fma_f32 v[48:49], v[48:49], v[32:33], v[24:25]
    v_pk_fma_f32 v[50:51], v[50:51], v[34:35], v[26:27]
    v_pk_fma_f32 v[52:53], v[52:53], v[36:37], v[28:29]
    v_pk_fma_f32 v[54:55], v[54:55], v[38:39], v[30:31]
    v_cvt_pk_bf16_f32 v104, v48, v49
    v_cvt_pk_bf16_f32 v105, v50, v51
    v_cvt_pk_bf16_f32 v106, v52, v53
    v_cvt_pk_bf16_f32 v107, v54, v55
    ds_write_b128 v6, v[104:107] offset:4096
    v_pk_mul_f32 v[56:57], v[56:57], v[98:99]
    v_pk_mul_f32 v[58:59], v[58:59], v[98:99]
    v_pk_mul_f32 v[60:61], v[60:61], v[98:99]
    v_pk_mul_f32 v[62:63], v[62:63], v[98:99]
    s_waitcnt lgkmcnt(1)
    ds_read_b128 v[24:27], v5 offset:768
    ds_read_b128 v[28:31], v5 offset:784
    ds_read_b128 v[32:35], v5 offset:2560
    ds_read_b128 v[36:39], v5 offset:2576
    v_pk_fma_f32 v[56:57], v[56:57], v[16:17], v[8:9]
    v_pk_fma_f32 v[58:59], v[58:59], v[18:19], v[10:11]
    v_pk_fma_f32 v[60:61], v[60:61], v[20:21], v[12:13]
    v_pk_fma_f32 v[62:63], v[62:63], v[22:23], v[14:15]
    v_cvt_pk_bf16_f32 v100, v56, v57
    v_cvt_pk_bf16_f32 v101, v58, v59
    v_cvt_pk_bf16_f32 v102, v60, v61
    v_cvt_pk_bf16_f32 v103, v62, v63
    ds_write_b128 v6, v[100:103] offset:8192
    v_pk_mul_f32 v[64:65], v[64:65], v[98:99]
    v_pk_mul_f32 v[66:67], v[66:67], v[98:99]
    v_pk_mul_f32 v[68:69], v[68:69], v[98:99]
    v_pk_mul_f32 v[70:71], v[70:71], v[98:99]
    s_waitcnt lgkmcnt(1)
    ds_read_b128 v[8:11], v5 offset:1024
    ds_read_b128 v[12:15], v5 offset:1040
    ds_read_b128 v[16:19], v5 offset:2816
    ds_read_b128 v[20:23], v5 offset:2832
    v_pk_fma_f32 v[64:65], v[64:65], v[32:33], v[24:25]
    v_pk_fma_f32 v[66:67], v[66:67], v[34:35], v[26:27]
    v_pk_fma_f32 v[68:69], v[68:69], v[36:37], v[28:29]
    v_pk_fma_f32 v[70:71], v[70:71], v[38:39], v[30:31]
    v_cvt_pk_bf16_f32 v104, v64, v65
    v_cvt_pk_bf16_f32 v105, v66, v67
    v_cvt_pk_bf16_f32 v106, v68, v69
    v_cvt_pk_bf16_f32 v107, v70, v71
    ds_write_b128 v6, v[104:107] offset:12288
    v_pk_mul_f32 v[72:73], v[72:73], v[98:99]
    v_pk_mul_f32 v[74:75], v[74:75], v[98:99]
    v_pk_mul_f32 v[76:77], v[76:77], v[98:99]
    v_pk_mul_f32 v[78:79], v[78:79], v[98:99]
    s_waitcnt lgkmcnt(1)
    ds_read_b128 v[24:27], v5 offset:1280
    ds_read_b128 v[28:31], v5 offset:1296
    ds_read_b128 v[32:35], v5 offset:3072
    ds_read_b128 v[36:39], v5 offset:3088
    v_pk_fma_f32 v[72:73], v[72:73], v[16:17], v[8:9]
    v_pk_fma_f32 v[74:75], v[74:75], v[18:19], v[10:11]
    v_pk_fma_f32 v[76:77], v[76:77], v[20:21], v[12:13]
    v_pk_fma_f32 v[78:79], v[78:79], v[22:23], v[14:15]
    v_cvt_pk_bf16_f32 v100, v72, v73
    v_cvt_pk_bf16_f32 v101, v74, v75
    v_cvt_pk_bf16_f32 v102, v76, v77
    v_cvt_pk_bf16_f32 v103, v78, v79
    ds_write_b128 v6, v[100:103] offset:16384
    v_pk_mul_f32 v[80:81], v[80:81], v[98:99]
    v_pk_mul_f32 v[82:83], v[82:83], v[98:99]
    v_pk_mul_f32 v[84:85], v[84:85], v[98:99]
    v_pk_mul_f32 v[86:87], v[86:87], v[98:99]
    s_waitcnt lgkmcnt(1)
    ds_read_b128 v[8:11], v5 offset:1536
    ds_read_b128 v[12:15], v5 offset:1552
    ds_read_b128 v[16:19], v5 offset:3328
    ds_read_b128 v[20:23], v5 offset:3344
    v_pk_fma_f32 v[80:81], v[80:81], v[32:33], v[24:25]
    v_pk_fma_f32 v[82:83], v[82:83], v[34:35], v[26:27]
    v_pk_fma_f32 v[84:85], v[84:85], v[36:37], v[28:29]
    v_pk_fma_f32 v[86:87], v[86:87], v[38:39], v[30:31]
    v_cvt_pk_bf16_f32 v104, v80, v81
    v_cvt_pk_bf16_f32 v105, v82, v83
    v_cvt_pk_bf16_f32 v106, v84, v85
    v_cvt_pk_bf16_f32 v107, v86, v87
    ds_write_b128 v6, v[104:107] offset:20480
    v_pk_mul_f32 v[88:89], v[88:89], v[98:99]
    v_pk_mul_f32 v[90:91], v[90:91], v[98:99]
    v_pk_mul_f32 v[92:93], v[92:93], v[98:99]
    v_pk_mul_f32 v[94:95], v[94:95], v[98:99]
    s_waitcnt lgkmcnt(0)
    v_pk_fma_f32 v[88:89], v[88:89], v[16:17], v[8:9]
    v_pk_fma_f32 v[90:91], v[90:91], v[18:19], v[10:11]
    v_pk_fma_f32 v[92:93], v[92:93], v[20:21], v[12:13]
    v_pk_fma_f32 v[94:95], v[94:95], v[22:23], v[14:15]
    v_cvt_pk_bf16_f32 v100, v88, v89
    v_cvt_pk_bf16_f32 v101, v90, v91
    v_cvt_pk_bf16_f32 v102, v92, v93
    v_cvt_pk_bf16_f32 v103, v94, v95
    ds_write_b128 v6, v[100:103] offset:24576
    s_waitcnt lgkmcnt(0)
    s_barrier
    s_endpgm
mlp1_kernel_gemm:
    s_add_u32 s56, s36, 0xeb0000
    s_addc_u32 s57, s37, 0
    s_mov_b32 s58, 0x700000
    s_mov_b32 s59, 0x20000
    ds_read_b128 v[40:43], v7 offset:0
    ds_read_b128 v[44:47], v7 offset:28672
    ds_read_b128 v[48:51], v7 offset:1024
    ds_read_b128 v[52:55], v7 offset:29696
    ds_read_b128 v[56:59], v7 offset:2048
    ds_read_b128 v[60:63], v7 offset:30720
    ds_read_b128 v[64:67], v7 offset:3072
    ds_read_b128 v[68:71], v7 offset:31744
    s_waitcnt lgkmcnt(6)
    s_waitcnt vmcnt(27)
    v_mfma_f32_32x32x16_bf16 v[8:23], v[128:131], v[40:43], 0
    v_mfma_f32_32x32x16_bf16 v[24:39], v[128:131], v[44:47], 0
    ds_read_b128 v[40:43], v7 offset:4096
    ds_read_b128 v[44:47], v7 offset:32768
    s_waitcnt lgkmcnt(6)
    s_waitcnt vmcnt(26)
    v_mfma_f32_32x32x16_bf16 v[8:23], v[132:135], v[48:51], v[8:23]
    v_mfma_f32_32x32x16_bf16 v[24:39], v[132:135], v[52:55], v[24:39]
    ds_read_b128 v[48:51], v7 offset:5120
    ds_read_b128 v[52:55], v7 offset:33792
    s_waitcnt lgkmcnt(6)
    s_waitcnt vmcnt(25)
    v_mfma_f32_32x32x16_bf16 v[8:23], v[136:139], v[56:59], v[8:23]
    v_mfma_f32_32x32x16_bf16 v[24:39], v[136:139], v[60:63], v[24:39]
    ds_read_b128 v[56:59], v7 offset:6144
    ds_read_b128 v[60:63], v7 offset:34816
    s_waitcnt lgkmcnt(6)
    s_waitcnt vmcnt(24)
    v_mfma_f32_32x32x16_bf16 v[8:23], v[140:143], v[64:67], v[8:23]
    v_mfma_f32_32x32x16_bf16 v[24:39], v[140:143], v[68:71], v[24:39]
    ds_read_b128 v[64:67], v7 offset:7168
    ds_read_b128 v[68:71], v7 offset:35840
    s_waitcnt lgkmcnt(6)
    s_waitcnt vmcnt(23)
    v_mfma_f32_32x32x16_bf16 v[8:23], v[144:147], v[40:43], v[8:23]
    v_mfma_f32_32x32x16_bf16 v[24:39], v[144:147], v[44:47], v[24:39]
    ds_read_b128 v[40:43], v7 offset:8192
    ds_read_b128 v[44:47], v7 offset:36864
    s_waitcnt lgkmcnt(6)
    s_waitcnt vmcnt(22)
    v_mfma_f32_32x32x16_bf16 v[8:23], v[148:151], v[48:51], v[8:23]
    v_mfma_f32_32x32x16_bf16 v[24:39], v[148:151], v[52:55], v[24:39]
    ds_read_b128 v[48:51], v7 offset:9216
    ds_read_b128 v[52:55], v7 offset:37888
    s_waitcnt lgkmcnt(6)
    s_waitcnt vmcnt(21)
    v_mfma_f32_32x32x16_bf16 v[8:23], v[152:155], v[56:59], v[8:23]
    v_mfma_f32_32x32x16_bf16 v[24:39], v[152:155], v[60:63], v[24:39]
    ds_read_b128 v[56:59], v7 offset:10240
    ds_read_b128 v[60:63], v7 offset:38912
    s_waitcnt lgkmcnt(6)
    s_waitcnt vmcnt(20)
    v_mfma_f32_32x32x16_bf16 v[8:23], v[156:159], v[64:67], v[8:23]
    v_mfma_f32_32x32x16_bf16 v[24:39], v[156:159], v[68:71], v[24:39]
    ds_read_b128 v[64:67], v7 offset:11264
    ds_read_b128 v[68:71], v7 offset:39936
    s_waitcnt lgkmcnt(6)
    s_waitcnt vmcnt(19)
    v_mfma_f32_32x32x16_bf16 v[8:23], v[160:163], v[40:43], v[8:23]
    v_mfma_f32_32x32x16_bf16 v[24:39], v[160:163], v[44:47], v[24:39]
    ds_read_b128 v[40:43], v7 offset:12288
    ds_read_b128 v[44:47], v7 offset:40960
    s_waitcnt lgkmcnt(6)
    s_waitcnt vmcnt(18)
    v_mfma_f32_32x32x16_bf16 v[8:23], v[164:167], v[48:51], v[8:23]
    v_mfma_f32_32x32x16_bf16 v[24:39], v[164:167], v[52:55], v[24:39]
    ds_read_b128 v[48:51], v7 offset:13312
    ds_read_b128 v[52:55], v7 offset:41984
    s_waitcnt lgkmcnt(6)
    s_waitcnt vmcnt(17)
    v_mfma_f32_32x32x16_bf16 v[8:23], v[168:171], v[56:59], v[8:23]
    v_mfma_f32_32x32x16_bf16 v[24:39], v[168:171], v[60:63], v[24:39]
    ds_read_b128 v[56:59], v7 offset:14336
    ds_read_b128 v[60:63], v7 offset:43008
    s_waitcnt lgkmcnt(6)
    s_waitcnt vmcnt(16)
    v_mfma_f32_32x32x16_bf16 v[8:23], v[172:175], v[64:67], v[8:23]
    v_mfma_f32_32x32x16_bf16 v[24:39], v[172:175], v[68:71], v[24:39]
    ds_read_b128 v[64:67], v7 offset:15360
    ds_read_b128 v[68:71], v7 offset:44032
    s_waitcnt lgkmcnt(6)
    s_waitcnt vmcnt(15)
    v_mfma_f32_32x32x16_bf16 v[8:23], v[176:179], v[40:43], v[8:23]
    v_mfma_f32_32x32x16_bf16 v[24:39], v[176:179], v[44:47], v[24:39]
    ds_read_b128 v[40:43], v7 offset:16384
    ds_read_b128 v[44:47], v7 offset:45056
    s_waitcnt lgkmcnt(6)
    s_waitcnt vmcnt(14)
    v_mfma_f32_32x32x16_bf16 v[8:23], v[180:183], v[48:51], v[8:23]
    v_mfma_f32_32x32x16_bf16 v[24:39], v[180:183], v[52:55], v[24:39]
    ds_read_b128 v[48:51], v7 offset:17408
    ds_read_b128 v[52:55], v7 offset:46080
    s_waitcnt lgkmcnt(6)
    s_waitcnt vmcnt(13)
    v_mfma_f32_32x32x16_bf16 v[8:23], v[184:187], v[56:59], v[8:23]
    v_mfma_f32_32x32x16_bf16 v[24:39], v[184:187], v[60:63], v[24:39]
    ds_read_b128 v[56:59], v7 offset:18432
    ds_read_b128 v[60:63], v7 offset:47104
    s_waitcnt lgkmcnt(6)
    s_waitcnt vmcnt(12)
    v_mfma_f32_32x32x16_bf16 v[8:23], v[188:191], v[64:67], v[8:23]
    v_mfma_f32_32x32x16_bf16 v[24:39], v[188:191], v[68:71], v[24:39]
    ds_read_b128 v[64:67], v7 offset:19456
    ds_read_b128 v[68:71], v7 offset:48128
    s_waitcnt lgkmcnt(6)
    s_waitcnt vmcnt(11)
    v_mfma_f32_32x32x16_bf16 v[8:23], v[192:195], v[40:43], v[8:23]
    v_mfma_f32_32x32x16_bf16 v[24:39], v[192:195], v[44:47], v[24:39]
    ds_read_b128 v[40:43], v7 offset:20480
    ds_read_b128 v[44:47], v7 offset:49152
    s_waitcnt lgkmcnt(6)
    s_waitcnt vmcnt(10)
    v_mfma_f32_32x32x16_bf16 v[8:23], v[196:199], v[48:51], v[8:23]
    v_mfma_f32_32x32x16_bf16 v[24:39], v[196:199], v[52:55], v[24:39]
    ds_read_b128 v[48:51], v7 offset:21504
    ds_read_b128 v[52:55], v7 offset:50176
    s_waitcnt lgkmcnt(6)
    s_waitcnt vmcnt(9)
    v_mfma_f32_32x32x16_bf16 v[8:23], v[200:203], v[56:59], v[8:23]
    v_mfma_f32_32x32x16_bf16 v[24:39], v[200:203], v[60:63], v[24:39]
    ds_read_b128 v[56:59], v7 offset:22528
    ds_read_b128 v[60:63], v7 offset:51200
    s_waitcnt lgkmcnt(6)
    s_waitcnt vmcnt(8)
    v_mfma_f32_32x32x16_bf16 v[8:23], v[204:207], v[64:67], v[8:23]
    v_mfma_f32_32x32x16_bf16 v[24:39], v[204:207], v[68:71], v[24:39]
    ds_read_b128 v[64:67], v7 offset:23552
    ds_read_b128 v[68:71], v7 offset:52224
    s_waitcnt lgkmcnt(6)
    s_waitcnt vmcnt(7)
    v_mfma_f32_32x32x16_bf16 v[8:23], v[208:211], v[40:43], v[8:23]
    v_mfma_f32_32x32x16_bf16 v[24:39], v[208:211], v[44:47], v[24:39]
    ds_read_b128 v[40:43], v7 offset:24576
    ds_read_b128 v[44:47], v7 offset:53248
    s_waitcnt lgkmcnt(6)
    s_waitcnt vmcnt(6)
    v_mfma_f32_32x32x16_bf16 v[8:23], v[212:215], v[48:51], v[8:23]
    v_mfma_f32_32x32x16_bf16 v[24:39], v[212:215], v[52:55], v[24:39]
    ds_read_b128 v[48:51], v7 offset:25600
    ds_read_b128 v[52:55], v7 offset:54272
    s_waitcnt lgkmcnt(6)
    s_waitcnt vmcnt(5)
    v_mfma_f32_32x32x16_bf16 v[8:23], v[216:219], v[56:59], v[8:23]
    v_mfma_f32_32x32x16_bf16 v[24:39], v[216:219], v[60:63], v[24:39]
    ds_read_b128 v[56:59], v7 offset:26624
    ds_read_b128 v[60:63], v7 offset:55296
    s_waitcnt lgkmcnt(6)
    s_waitcnt vmcnt(4)
    v_mfma_f32_32x32x16_bf16 v[8:23], v[220:223], v[64:67], v[8:23]
    v_mfma_f32_32x32x16_bf16 v[24:39], v[220:223], v[68:71], v[24:39]
    ds_read_b128 v[64:67], v7 offset:27648
    ds_read_b128 v[68:71], v7 offset:56320
    s_waitcnt lgkmcnt(6)
    s_waitcnt vmcnt(3)
    v_mfma_f32_32x32x16_bf16 v[8:23], v[224:227], v[40:43], v[8:23]
    v_mfma_f32_32x32x16_bf16 v[24:39], v[224:227], v[44:47], v[24:39]
    s_waitcnt lgkmcnt(4)
    s_waitcnt vmcnt(2)
    v_mfma_f32_32x32x16_bf16 v[8:23], v[228:231], v[48:51], v[8:23]
    v_mfma_f32_32x32x16_bf16 v[24:39], v[228:231], v[52:55], v[24:39]
    s_waitcnt lgkmcnt(2)
    s_waitcnt vmcnt(1)
    v_mfma_f32_32x32x16_bf16 v[8:23], v[232:235], v[56:59], v[8:23]
    v_mfma_f32_32x32x16_bf16 v[24:39], v[232:235], v[60:63], v[24:39]
    s_waitcnt lgkmcnt(0)
    s_waitcnt vmcnt(0)
    v_mfma_f32_32x32x16_bf16 v[8:23], v[236:239], v[64:67], v[8:23]
    v_mfma_f32_32x32x16_bf16 v[24:39], v[236:239], v[68:71], v[24:39]
    s_nop 15
    v_mul_f32 v80, 0xbfb8aa3b, v8
    v_mul_f32 v81, 0xbfb8aa3b, v9
    v_mul_f32 v82, 0xbfb8aa3b, v10
    v_mul_f32 v83, 0xbfb8aa3b, v11
    v_mul_f32 v84, 0xbfb8aa3b, v12
    v_mul_f32 v85, 0xbfb8aa3b, v13
    v_mul_f32 v86, 0xbfb8aa3b, v14
    v_mul_f32 v87, 0xbfb8aa3b, v15
    v_mul_f32 v88, 0xbfb8aa3b, v16
    v_mul_f32 v89, 0xbfb8aa3b, v17
    v_mul_f32 v90, 0xbfb8aa3b, v18
    v_mul_f32 v91, 0xbfb8aa3b, v19
    v_mul_f32 v92, 0xbfb8aa3b, v20
    v_mul_f32 v93, 0xbfb8aa3b, v21
    v_mul_f32 v94, 0xbfb8aa3b, v22
    v_mul_f32 v95, 0xbfb8aa3b, v23
    v_mul_f32 v96, 0xbfb8aa3b, v24
    v_mul_f32 v97, 0xbfb8aa3b, v25
    v_mul_f32 v98, 0xbfb8aa3b, v26
    v_mul_f32 v99, 0xbfb8aa3b, v27
    v_mul_f32 v100, 0xbfb8aa3b, v28
    v_mul_f32 v101, 0xbfb8aa3b, v29
    v_mul_f32 v102, 0xbfb8aa3b, v30
    v_mul_f32 v103, 0xbfb8aa3b, v31
    v_mul_f32 v104, 0xbfb8aa3b, v32
    v_mul_f32 v105, 0xbfb8aa3b, v33
    v_mul_f32 v106, 0xbfb8aa3b, v34
    v_mul_f32 v107, 0xbfb8aa3b, v35
    v_mul_f32 v108, 0xbfb8aa3b, v36
    v_mul_f32 v109, 0xbfb8aa3b, v37
    v_mul_f32 v110, 0xbfb8aa3b, v38
    v_mul_f32 v111, 0xbfb8aa3b, v39
    v_exp_f32 v80, v80
    v_exp_f32 v81, v81
    v_exp_f32 v82, v82
    v_exp_f32 v83, v83
    v_exp_f32 v84, v84
    v_exp_f32 v85, v85
    v_exp_f32 v86, v86
    v_exp_f32 v87, v87
    v_exp_f32 v88, v88
    v_exp_f32 v89, v89
    v_exp_f32 v90, v90
    v_exp_f32 v91, v91
    v_exp_f32 v92, v92
    v_exp_f32 v93, v93
    v_exp_f32 v94, v94
    v_exp_f32 v95, v95
    v_exp_f32 v96, v96
    v_exp_f32 v97, v97
    v_exp_f32 v98, v98
    v_exp_f32 v99, v99
    v_exp_f32 v100, v100
    v_exp_f32 v101, v101
    v_exp_f32 v102, v102
    v_exp_f32 v103, v103
    v_exp_f32 v104, v104
    v_exp_f32 v105, v105
    v_exp_f32 v106, v106
    v_exp_f32 v107, v107
    v_exp_f32 v108, v108
    v_exp_f32 v109, v109
    v_exp_f32 v110, v110
    v_exp_f32 v111, v111
    v_add_f32 v80, 1.0, v80
    v_add_f32 v81, 1.0, v81
    v_add_f32 v82, 1.0, v82
    v_add_f32 v83, 1.0, v83
    v_add_f32 v84, 1.0, v84
    v_add_f32 v85, 1.0, v85
    v_add_f32 v86, 1.0, v86
    v_add_f32 v87, 1.0, v87
    v_add_f32 v88, 1.0, v88
    v_add_f32 v89, 1.0, v89
    v_add_f32 v90, 1.0, v90
    v_add_f32 v91, 1.0, v91
    v_add_f32 v92, 1.0, v92
    v_add_f32 v93, 1.0, v93
    v_add_f32 v94, 1.0, v94
    v_add_f32 v95, 1.0, v95
    v_add_f32 v96, 1.0, v96
    v_add_f32 v97, 1.0, v97
    v_add_f32 v98, 1.0, v98
    v_add_f32 v99, 1.0, v99
    v_add_f32 v100, 1.0, v100
    v_add_f32 v101, 1.0, v101
    v_add_f32 v102, 1.0, v102
    v_add_f32 v103, 1.0, v103
    v_add_f32 v104, 1.0, v104
    v_add_f32 v105, 1.0, v105
    v_add_f32 v106, 1.0, v106
    v_add_f32 v107, 1.0, v107
    v_add_f32 v108, 1.0, v108
    v_add_f32 v109, 1.0, v109
    v_add_f32 v110, 1.0, v110
    v_add_f32 v111, 1.0, v111
    v_rcp_f32 v80, v80
    v_rcp_f32 v81, v81
    v_rcp_f32 v82, v82
    v_rcp_f32 v83, v83
    v_rcp_f32 v84, v84
    v_rcp_f32 v85, v85
    v_rcp_f32 v86, v86
    v_rcp_f32 v87, v87
    v_rcp_f32 v88, v88
    v_rcp_f32 v89, v89
    v_rcp_f32 v90, v90
    v_rcp_f32 v91, v91
    v_rcp_f32 v92, v92
    v_rcp_f32 v93, v93
    v_rcp_f32 v94, v94
    v_rcp_f32 v95, v95
    v_rcp_f32 v96, v96
    v_rcp_f32 v97, v97
    v_rcp_f32 v98, v98
    v_rcp_f32 v99, v99
    v_rcp_f32 v100, v100
    v_rcp_f32 v101, v101
    v_rcp_f32 v102, v102
    v_rcp_f32 v103, v103
    v_rcp_f32 v104, v104
    v_rcp_f32 v105, v105
    v_rcp_f32 v106, v106
    v_rcp_f32 v107, v107
    v_rcp_f32 v108, v108
    v_rcp_f32 v109, v109
    v_rcp_f32 v110, v110
    v_rcp_f32 v111, v111
    v_mul_f32 v8, v8, v80
    v_mul_f32 v9, v9, v81
    v_mul_f32 v10, v10, v82
    v_mul_f32 v11, v11, v83
    v_mul_f32 v12, v12, v84
    v_mul_f32 v13, v13, v85
    v_mul_f32 v14, v14, v86
    v_mul_f32 v15, v15, v87
    v_mul_f32 v16, v16, v88
    v_mul_f32 v17, v17, v89
    v_mul_f32 v18, v18, v90
    v_mul_f32 v19, v19, v91
    v_mul_f32 v20, v20, v92
    v_mul_f32 v21, v21, v93
    v_mul_f32 v22, v22, v94
    v_mul_f32 v23, v23, v95
    v_mul_f32 v24, v24, v96
    v_mul_f32 v25, v25, v97
    v_mul_f32 v26, v26, v98
    v_mul_f32 v27, v27, v99
    v_mul_f32 v28, v28, v100
    v_mul_f32 v29, v29, v101
    v_mul_f32 v30, v30, v102
    v_mul_f32 v31, v31, v103
    v_mul_f32 v32, v32, v104
    v_mul_f32 v33, v33, v105
    v_mul_f32 v34, v34, v106
    v_mul_f32 v35, v35, v107
    v_mul_f32 v36, v36, v108
    v_mul_f32 v37, v37, v109
    v_mul_f32 v38, v38, v110
    v_mul_f32 v39, v39, v111
    s_lshl_b32 s66, s41, 1
    s_mul_i32 s66, s66, 114688
    s_lshl_b32 s67, s62, 11
    s_add_u32 s66, s66, s67
    s_add_u32 s67, s66, 114688
    v_cvt_pk_bf16_f32 v72, v8, v9
    v_cvt_pk_bf16_f32 v73, v10, v11
    v_cvt_pk_bf16_f32 v74, v12, v13
    v_cvt_pk_bf16_f32 v75, v14, v15
    v_cvt_pk_bf16_f32 v76, v16, v17
    v_cvt_pk_bf16_f32 v77, v18, v19
    v_cvt_pk_bf16_f32 v78, v20, v21
    v_cvt_pk_bf16_f32 v79, v22, v23
    buffer_store_dwordx4 v[72:75], v7, s[56:59], s66 offen sc1
    buffer_store_dwordx4 v[76:79], v7, s[56:59], s66 offen offset:1024 sc1
    s_nop 1
    v_cvt_pk_bf16_f32 v72, v24, v25
    v_cvt_pk_bf16_f32 v73, v26, v27
    v_cvt_pk_bf16_f32 v74, v28, v29
    v_cvt_pk_bf16_f32 v75, v30, v31
    v_cvt_pk_bf16_f32 v76, v32, v33
    v_cvt_pk_bf16_f32 v77, v34, v35
    v_cvt_pk_bf16_f32 v78, v36, v37
    v_cvt_pk_bf16_f32 v79, v38, v39
    buffer_store_dwordx4 v[72:75], v7, s[56:59], s67 offen sc1
    buffer_store_dwordx4 v[76:79], v7, s[56:59], s67 offen offset:1024 sc1
    s_nop 1
mlp1_kernel_end:
    s_endpgm
.globl mlp2_kernel
.p2align 8
.type mlp2_kernel,@function
mlp2_kernel:
    s_cmp_ge_u32 s2, 224
    s_cbranch_scc1 mlp2_kernel_end
    s_load_dwordx16 s[16:31], s[0:1], 0
    s_load_dwordx4 s[32:35], s[0:1], 64
    s_load_dwordx2 s[36:37], s[0:1], 80
    v_lshrrev_b32 v1, 6, v0
    v_and_b32 v2, 63, v0
    v_readfirstlane_b32 s40, v1
    s_and_b32 s41, s2, 31
    s_lshr_b32 s42, s2, 5
    v_lshlrev_b32 v3, 4, v2
    s_waitcnt lgkmcnt(0)
    s_add_u32 s44, s36, 0xeb0000
    s_addc_u32 s45, s37, 0
    s_mov_b32 s46, 0x700000
    s_mov_b32 s47, 0x20000
    s_add_u32 s48, s36, 0x360000
    s_addc_u32 s49, s37, 0
    s_mov_b32 s50, 0x188000
    s_mov_b32 s51, 0x20000
    s_add_u32 s52, s36, 0xcf0000
    s_addc_u32 s53, s37, 0
    s_mov_b32 s54, 0x1c0000
    s_mov_b32 s55, 0x20000
    s_add_u32 s56, s36, 0x2300
    s_addc_u32 s57, s37, 0
    s_mov_b32 s58, 0x700
    s_mov_b32 s59, 0x20000
    s_mov_b32 s60, s32
    s_mov_b32 s61, s33
    s_mov_b32 s62, 0x1c0000
    s_mov_b32 s63, 0x20000
    s_mul_i32 s64, s40, 14336
    s_mul_i32 s65, s41, 229376
    s_add_u32 s65, s65, s64
    s_add_u32 s66, s65, 114688
    s_mul_i32 s67, s42, 229376
    s_add_u32 s67, s67, s64
    s_add_u32 s68, s67, 114688
    buffer_load_dwordx4 v[80:83], v3, s[44:47], s65 offen offset:0
    buffer_load_dwordx4 v[84:87], v3, s[44:47], s66 offen offset:0
    buffer_load_dwordx4 v[88:91], v3, s[48:51], s67 offen offset:0
    buffer_load_dwordx4 v[92:95], v3, s[48:51], s68 offen offset:0
    buffer_load_dwordx4 v[96:99], v3, s[44:47], s65 offen offset:1024
    buffer_load_dwordx4 v[100:103], v3, s[44:47], s66 offen offset:1024
    buffer_load_dwordx4 v[104:107], v3, s[48:51], s67 offen offset:1024
    buffer_load_dwordx4 v[108:111], v3, s[48:51], s68 offen offset:1024
    buffer_load_dwordx4 v[112:115], v3, s[44:47], s65 offen offset:2048
    buffer_load_dwordx4 v[116:119], v3, s[44:47], s66 offen offset:2048
    buffer_load_dwordx4 v[120:123], v3, s[48:51], s67 offen offset:2048
    buffer_load_dwordx4 v[124:127], v3, s[48:51], s68 offen offset:2048
    buffer_load_dwordx4 v[128:131], v3, s[44:47], s65 offen offset:3072
    buffer_load_dwordx4 v[132:135], v3, s[44:47], s66 offen offset:3072
    buffer_load_dwordx4 v[136:139], v3, s[48:51], s67 offen offset:3072
    buffer_load_dwordx4 v[140:143], v3, s[48:51], s68 offen offset:3072
    s_add_u32 s65, s65, 4096
    s_add_u32 s66, s66, 4096
    s_add_u32 s67, s67, 4096
    s_add_u32 s68, s68, 4096
    buffer_load_dwordx4 v[144:147], v3, s[44:47], s65 offen offset:0
    buffer_load_dwordx4 v[148:151], v3, s[44:47], s66 offen offset:0
    buffer_load_dwordx4 v[152:155], v3, s[48:51], s67 offen offset:0
    buffer_load_dwordx4 v[156:159], v3, s[48:51], s68 offen offset:0
    buffer_load_dwordx4 v[160:163], v3, s[44:47], s65 offen offset:1024
    buffer_load_dwordx4 v[164:167], v3, s[44:47], s66 offen offset:1024
    buffer_load_dwordx4 v[168:171], v3, s[48:51], s67 offen offset:1024
    buffer_load_dwordx4 v[172:175], v3, s[48:51], s68 offen offset:1024
    buffer_load_dwordx4 v[176:179], v3, s[44:47], s65 offen offset:2048
    buffer_load_dwordx4 v[180:183], v3, s[44:47], s66 offen offset:2048
    buffer_load_dwordx4 v[184:187], v3, s[48:51], s67 offen offset:2048
    buffer_load_dwordx4 v[188:191], v3, s[48:51], s68 offen offset:2048
    buffer_load_dwordx4 v[192:195], v3, s[44:47], s65 offen offset:3072
    buffer_load_dwordx4 v[196:199], v3, s[44:47], s66 offen offset:3072
    buffer_load_dwordx4 v[200:203], v3, s[48:51], s67 offen offset:3072
    buffer_load_dwordx4 v[204:207], v3, s[48:51], s68 offen offset:3072
    s_add_u32 s65, s65, 4096
    s_add_u32 s66, s66, 4096
    s_add_u32 s67, s67, 4096
    s_add_u32 s68, s68, 4096
    s_waitcnt vmcnt(28)
    v_mfma_f32_32x32x16_bf16 v[8:23], v[88:91], v[80:83], 0
    v_mfma_f32_32x32x16_bf16 v[24:39], v[92:95], v[80:83], 0
    v_mfma_f32_32x32x16_bf16 v[40:55], v[88:91], v[84:87], 0
    v_mfma_f32_32x32x16_bf16 v[56:71], v[92:95], v[84:87], 0
    buffer_load_dwordx4 v[80:83], v3, s[44:47], s65 offen offset:0
    buffer_load_dwordx4 v[84:87], v3, s[44:47], s66 offen offset:0
    buffer_load_dwordx4 v[88:91], v3, s[48:51], s67 offen offset:0
    buffer_load_dwordx4 v[92:95], v3, s[48:51], s68 offen offset:0
    s_waitcnt vmcnt(28)
    v_mfma_f32_32x32x16_bf16 v[8:23], v[104:107], v[96:99], v[8:23]
    v_mfma_f32_32x32x16_bf16 v[24:39], v[108:111], v[96:99], v[24:39]
    v_mfma_f32_32x32x16_bf16 v[40:55], v[104:107], v[100:103], v[40:55]
    v_mfma_f32_32x32x16_bf16 v[56:71], v[108:111], v[100:103], v[56:71]
    buffer_load_dwordx4 v[96:99], v3, s[44:47], s65 offen offset:1024
    buffer_load_dwordx4 v[100:103], v3, s[44:47], s66 offen offset:1024
    buffer_load_dwordx4 v[104:107], v3, s[48:51], s67 offen offset:1024
    buffer_load_dwordx4 v[108:111], v3, s[48:51], s68 offen offset:1024
    s_waitcnt vmcnt(28)
    v_mfma_f32_32x32x16_bf16 v[8:23], v[120:123], v[112:115], v[8:23]
    v_mfma_f32_32x32x16_bf16 v[24:39], v[124:127], v[112:115], v[24:39]
    v_mfma_f32_32x32x16_bf16 v[40:55], v[120:123], v[116:119], v[40:55]
    v_mfma_f32_32x32x16_bf16 v[56:71], v[124:127], v[116:119], v[56:71]
    buffer_load_dwordx4 v[112:115], v3, s[44:47], s65 offen offset:2048
    buffer_load_dwordx4 v[116:119], v3, s[44:47], s66 offen offset:2048
    buffer_load_dwordx4 v[120:123], v3, s[48:51], s67 offen offset:2048
    buffer_load_dwordx4 v[124:127], v3, s[48:51], s68 offen offset:2048
    s_waitcnt vmcnt(28)
    v_mfma_f32_32x32x16_bf16 v[8:23], v[136:139], v[128:131], v[8:23]
    v_mfma_f32_32x32x16_bf16 v[24:39], v[140:143], v[128:131], v[24:39]
    v_mfma_f32_32x32x16_bf16 v[40:55], v[136:139], v[132:135], v[40:55]
    v_mfma_f32_32x32x16_bf16 v[56:71], v[140:143], v[132:135], v[56:71]
    buffer_load_dwordx4 v[128:131], v3, s[44:47], s65 offen offset:3072
    buffer_load_dwordx4 v[132:135], v3, s[44:47], s66 offen offset:3072
    buffer_load_dwordx4 v[136:139], v3, s[48:51], s67 offen offset:3072
    buffer_load_dwordx4 v[140:143], v3, s[48:51], s68 offen offset:3072
    s_add_u32 s65, s65, 4096
    s_add_u32 s66, s66, 4096
    s_add_u32 s67, s67, 4096
    s_add_u32 s68, s68, 4096
    s_waitcnt vmcnt(28)
    v_mfma_f32_32x32x16_bf16 v[8:23], v[152:155], v[144:147], v[8:23]
    v_mfma_f32_32x32x16_bf16 v[24:39], v[156:159], v[144:147], v[24:39]
    v_mfma_f32_32x32x16_bf16 v[40:55], v[152:155], v[148:151], v[40:55]
    v_mfma_f32_32x32x16_bf16 v[56:71], v[156:159], v[148:151], v[56:71]
    buffer_load_dwordx4 v[144:147], v3, s[44:47], s65 offen offset:0
    buffer_load_dwordx4 v[148:151], v3, s[44:47], s66 offen offset:0
    buffer_load_dwordx4 v[152:155], v3, s[48:51], s67 offen offset:0
    buffer_load_dwordx4 v[156:159], v3, s[48:51], s68 offen offset:0
    s_waitcnt vmcnt(28)
    v_mfma_f32_32x32x16_bf16 v[8:23], v[168:171], v[160:163], v[8:23]
    v_mfma_f32_32x32x16_bf16 v[24:39], v[172:175], v[160:163], v[24:39]
    v_mfma_f32_32x32x16_bf16 v[40:55], v[168:171], v[164:167], v[40:55]
    v_mfma_f32_32x32x16_bf16 v[56:71], v[172:175], v[164:167], v[56:71]
    buffer_load_dwordx4 v[160:163], v3, s[44:47], s65 offen offset:1024
    buffer_load_dwordx4 v[164:167], v3, s[44:47], s66 offen offset:1024
    buffer_load_dwordx4 v[168:171], v3, s[48:51], s67 offen offset:1024
    buffer_load_dwordx4 v[172:175], v3, s[48:51], s68 offen offset:1024
    s_waitcnt vmcnt(28)
    v_mfma_f32_32x32x16_bf16 v[8:23], v[184:187], v[176:179], v[8:23]
    v_mfma_f32_32x32x16_bf16 v[24:39], v[188:191], v[176:179], v[24:39]
    v_mfma_f32_32x32x16_bf16 v[40:55], v[184:187], v[180:183], v[40:55]
    v_mfma_f32_32x32x16_bf16 v[56:71], v[188:191], v[180:183], v[56:71]
    s_waitcnt vmcnt(24)
    v_mfma_f32_32x32x16_bf16 v[8:23], v[200:203], v[192:195], v[8:23]
    v_mfma_f32_32x32x16_bf16 v[24:39], v[204:207], v[192:195], v[24:39]
    v_mfma_f32_32x32x16_bf16 v[40:55], v[200:203], v[196:199], v[40:55]
    v_mfma_f32_32x32x16_bf16 v[56:71], v[204:207], v[196:199], v[56:71]
    s_waitcnt vmcnt(20)
    v_mfma_f32_32x32x16_bf16 v[8:23], v[88:91], v[80:83], v[8:23]
    v_mfma_f32_32x32x16_bf16 v[24:39], v[92:95], v[80:83], v[24:39]
    v_mfma_f32_32x32x16_bf16 v[40:55], v[88:91], v[84:87], v[40:55]
    v_mfma_f32_32x32x16_bf16 v[56:71], v[92:95], v[84:87], v[56:71]
    s_waitcnt vmcnt(16)
    v_mfma_f32_32x32x16_bf16 v[8:23], v[104:107], v[96:99], v[8:23]
    v_mfma_f32_32x32x16_bf16 v[24:39], v[108:111], v[96:99], v[24:39]
    v_mfma_f32_32x32x16_bf16 v[40:55], v[104:107], v[100:103], v[40:55]
    v_mfma_f32_32x32x16_bf16 v[56:71], v[108:111], v[100:103], v[56:71]
    s_waitcnt vmcnt(12)
    v_mfma_f32_32x32x16_bf16 v[8:23], v[120:123], v[112:115], v[8:23]
    v_mfma_f32_32x32x16_bf16 v[24:39], v[124:127], v[112:115], v[24:39]
    v_mfma_f32_32x32x16_bf16 v[40:55], v[120:123], v[116:119], v[40:55]
    v_mfma_f32_32x32x16_bf16 v[56:71], v[124:127], v[116:119], v[56:71]
    s_waitcnt vmcnt(8)
    v_mfma_f32_32x32x16_bf16 v[8:23], v[136:139], v[128:131], v[8:23]
    v_mfma_f32_32x32x16_bf16 v[24:39], v[140:143], v[128:131], v[24:39]
    v_mfma_f32_32x32x16_bf16 v[40:55], v[136:139], v[132:135], v[40:55]
    v_mfma_f32_32x32x16_bf16 v[56:71], v[140:143], v[132:135], v[56:71]
    s_waitcnt vmcnt(4)
    v_mfma_f32_32x32x16_bf16 v[8:23], v[152:155], v[144:147], v[8:23]
    v_mfma_f32_32x32x16_bf16 v[24:39], v[156:159], v[144:147], v[24:39]
    v_mfma_f32_32x32x16_bf16 v[40:55], v[152:155], v[148:151], v[40:55]
    v_mfma_f32_32x32x16_bf16 v[56:71], v[156:159], v[148:151], v[56:71]
    s_waitcnt vmcnt(0)
    v_mfma_f32_32x32x16_bf16 v[8:23], v[168:171], v[160:163], v[8:23]
    v_mfma_f32_32x32x16_bf16 v[24:39], v[172:175], v[160:163], v[24:39]
    v_mfma_f32_32x32x16_bf16 v[40:55], v[168:171], v[164:167], v[40:55]
    v_mfma_f32_32x32x16_bf16 v[56:71], v[172:175], v[164:167], v[56:71]
    s_nop 15
    v_and_b32 v4, 31, v2
    v_mul_u32_u24 v4, 272, v4
    v_lshrrev_b32 v5, 5, v2
    v_lshl_add_u32 v4, v5, 4, v4
    s_mul_i32 s69, s40, 17408
    v_add_u32 v4, s69, v4
    ds_write_b128 v4, v[8:11] offset:0
    ds_write_b128 v4, v[12:15] offset:32
    ds_write_b128 v4, v[16:19] offset:64
    ds_write_b128 v4, v[20:23] offset:96
    ds_write_b128 v4, v[24:27] offset:128
    ds_write_b128 v4, v[28:31] offset:160
    ds_write_b128 v4, v[32:35] offset:192
    ds_write_b128 v4, v[36:39] offset:224
    ds_write_b128 v4, v[40:43] offset:8704
    ds_write_b128 v4, v[44:47] offset:8736
    ds_write_b128 v4, v[48:51] offset:8768
    ds_write_b128 v4, v[52:55] offset:8800
    ds_write_b128 v4, v[56:59] offset:8832
    ds_write_b128 v4, v[60:63] offset:8864
    ds_write_b128 v4, v[64:67] offset:8896
    ds_write_b128 v4, v[68:71] offset:8928
    v_lshrrev_b32 v5, 3, v0
    v_and_b32 v6, 7, v0
    s_lshl_b32 s69, s41, 6
    v_add_u32 v7, s69, v5
    v_mul_u32_u24 v7, 896, v7
    v_lshl_add_u32 v7, v6, 4, v7
    s_lshl_b32 s70, s42, 7
    buffer_load_dwordx4 v[72:75], v7, s[52:55], s70 offen
    v_lshlrev_b32 v76, 5, v6
    s_lshl_b32 s71, s42, 8
    buffer_load_dwordx4 v[80:83], v76, s[56:59], s71 offen
    buffer_load_dwordx4 v[84:87], v76, s[56:59], s71 offen offset:16
    v_mul_u32_u24 v4, 272, v5
    v_lshl_add_u32 v4, v6, 5, v4
    s_waitcnt lgkmcnt(0)
    s_barrier
    ds_read_b128 v[88:91], v4 offset:0
    ds_read_b128 v[92:95], v4 offset:16
    ds_read_b128 v[96:99], v4 offset:17408
    ds_read_b128 v[100:103], v4 offset:17424
    ds_read_b128 v[104:107], v4 offset:34816
    ds_read_b128 v[108:111], v4 offset:34832
    ds_read_b128 v[112:115], v4 offset:52224
    ds_read_b128 v[116:119], v4 offset:52240
    v_add_u32 v4, 69632, v4
    ds_read_b128 v[120:123], v4 offset:0
    ds_read_b128 v[124:127], v4 offset:16
    ds_read_b128 v[128:131], v4 offset:17408
    ds_read_b128 v[132:135], v4 offset:17424
    ds_read_b128 v[136:139], v4 offset:34816
    ds_read_b128 v[140:143], v4 offset:34832
    ds_read_b128 v[144:147], v4 offset:52224
    ds_read_b128 v[148:151], v4 offset:52240
    s_waitcnt lgkmcnt(0)
    v_add_f32 v88, v88, v96
    v_add_f32 v89, v89, v97
    v_add_f32 v90, v90, v98
    v_add_f32 v91, v91, v99
    v_add_f32 v92, v92, v100
    v_add_f32 v93, v93, v101
    v_add_f32 v94, v94, v102
    v_add_f32 v95, v95, v103
    v_add_f32 v88, v88, v104
    v_add_f32 v89, v89, v105
    v_add_f32 v90, v90, v106
    v_add_f32 v91, v91, v107
    v_add_f32 v92, v92, v108
    v_add_f32 v93, v93, v109
    v_add_f32 v94, v94, v110
    v_add_f32 v95, v95, v111
    v_add_f32 v88, v88, v112
    v_add_f32 v89, v89, v113
    v_add_f32 v90, v90, v114
    v_add_f32 v91, v91, v115
    v_add_f32 v92, v92, v116
    v_add_f32 v93, v93, v117
    v_add_f32 v94, v94, v118
    v_add_f32 v95, v95, v119
    v_add_f32 v88, v88, v120
    v_add_f32 v89, v89, v121
    v_add_f32 v90, v90, v122
    v_add_f32 v91, v91, v123
    v_add_f32 v92, v92, v124
    v_add_f32 v93, v93, v125
    v_add_f32 v94, v94, v126
    v_add_f32 v95, v95, v127
    v_add_f32 v88, v88, v128
    v_add_f32 v89, v89, v129
    v_add_f32 v90, v90, v130
    v_add_f32 v91, v91, v131
    v_add_f32 v92, v92, v132
    v_add_f32 v93, v93, v133
    v_add_f32 v94, v94, v134
    v_add_f32 v95, v95, v135
    v_add_f32 v88, v88, v136
    v_add_f32 v89, v89, v137
    v_add_f32 v90, v90, v138
    v_add_f32 v91, v91, v139
    v_add_f32 v92, v92, v140
    v_add_f32 v93, v93, v141
    v_add_f32 v94, v94, v142
    v_add_f32 v95, v95, v143
    v_add_f32 v88, v88, v144
    v_add_f32 v89, v89, v145
    v_add_f32 v90, v90, v146
    v_add_f32 v91, v91, v147
    v_add_f32 v92, v92, v148
    v_add_f32 v93, v93, v149
    v_add_f32 v94, v94, v150
    v_add_f32 v95, v95, v151
    s_waitcnt vmcnt(0)
    v_lshlrev_b32 v100, 16, v72
    v_and_b32 v101, 0xffff0000, v72
    v_lshlrev_b32 v102, 16, v73
    v_and_b32 v103, 0xffff0000, v73
    v_lshlrev_b32 v104, 16, v74
    v_and_b32 v105, 0xffff0000, v74
    v_lshlrev_b32 v106, 16, v75
    v_and_b32 v107, 0xffff0000, v75
    v_fmac_f32 v100, v88, v80
    v_fmac_f32 v101, v89, v81
    v_fmac_f32 v102, v90, v82
    v_fmac_f32 v103, v91, v83
    v_fmac_f32 v104, v92, v84
    v_fmac_f32 v105, v93, v85
    v_fmac_f32 v106, v94, v86
    v_fmac_f32 v107, v95, v87
    v_cvt_pk_bf16_f32 v108, v100, v101
    v_cvt_pk_bf16_f32 v109, v102, v103
    v_cvt_pk_bf16_f32 v110, v104, v105
    v_cvt_pk_bf16_f32 v111, v106, v107
    buffer_store_dwordx4 v[108:111], v7, s[60:63], s70 offen sc1
mlp2_kernel_end:
    s_endpgm
.section .rodata,"a"
.p2align 6
.amdhsa_kernel prep_kernel
  .amdhsa_next_free_vgpr 128
  .amdhsa_next_free_sgpr 100
  .amdhsa_accum_offset 128
  .amdhsa_group_segment_fixed_size 0
  .amdhsa_kernarg_size 88
  .amdhsa_user_sgpr_count 2
  .amdhsa_user_sgpr_kernarg_segment_ptr 1
  .amdhsa_system_sgpr_workgroup_id_x 1
.end_amdhsa_kernel
.p2align 6
.amdhsa_kernel qkv_kernel
  .amdhsa_next_free_vgpr 240
  .amdhsa_next_free_sgpr 100
  .amdhsa_accum_offset 240
  .amdhsa_group_segment_fixed_size 0
  .amdhsa_kernarg_size 88
  .amdhsa_user_sgpr_count 2
  .amdhsa_user_sgpr_kernarg_segment_ptr 1
  .amdhsa_system_sgpr_workgroup_id_x 1
.end_amdhsa_kernel
.p2align 6
.amdhsa_kernel attn_kernel
  .amdhsa_next_free_vgpr 128
  .amdhsa_next_free_sgpr 100
  .amdhsa_accum_offset 128
  .amdhsa_group_segment_fixed_size 0
  .amdhsa_kernarg_size 88
  .amdhsa_user_sgpr_count 2
  .amdhsa_user_sgpr_kernarg_segment_ptr 1
  .amdhsa_system_sgpr_workgroup_id_x 1
.end_amdhsa_kernel
.p2align 6
.amdhsa_kernel wo_kernel
  .amdhsa_next_free_vgpr 160
  .amdhsa_next_free_sgpr 100
  .amdhsa_accum_offset 160
  .amdhsa_group_segment_fixed_size 0
  .amdhsa_kernarg_size 88
  .amdhsa_user_sgpr_count 2
  .amdhsa_user_sgpr_kernarg_segment_ptr 1
  .amdhsa_system_sgpr_workgroup_id_x 1
.end_amdhsa_kernel
.p2align 6
.amdhsa_kernel mlp1_kernel
  .amdhsa_next_free_vgpr 240
  .amdhsa_next_free_sgpr 100
  .amdhsa_accum_offset 240
  .amdhsa_group_segment_fixed_size 0
  .amdhsa_kernarg_size 88
  .amdhsa_user_sgpr_count 2
  .amdhsa_user_sgpr_kernarg_segment_ptr 1
  .amdhsa_system_sgpr_workgroup_id_x 1
.end_amdhsa_kernel
.p2align 6
.amdhsa_kernel mlp2_kernel
  .amdhsa_next_free_vgpr 208
  .amdhsa_next_free_sgpr 100
  .amdhsa_accum_offset 208
  .amdhsa_group_segment_fixed_size 0
  .amdhsa_kernarg_size 88
  .amdhsa_user_sgpr_count 2
  .amdhsa_user_sgpr_kernarg_segment_ptr 1
  .amdhsa_system_sgpr_workgroup_id_x 1
.end_amdhsa_kernel
```
